```python
import torch

def _softmax(x, axis=-1):
    return torch.softmax(x, dim=axis)
def _gelu(x):
    return torch.nn.functional.gelu(x, approximate="tanh")
def _silu(x):
    return torch.nn.functional.silu(x)
def _sigmoid(x):
    return torch.sigmoid(x)
def _layernorm(x, axis=-1, eps=1e-5):
    m = x.mean(dim=axis, keepdim=True)
    v = x.var(dim=axis, keepdim=True, unbiased=False)
    return (x - m) / torch.sqrt(v + eps)
def _scatter_add(tgt, idx, src, axis=0):
    return tgt.clone().index_add_(axis, idx, src)
def _segment_sum(src, seg, n):
    out = torch.zeros((n,) + src.shape[1:], dtype=src.dtype)
    return out.index_add_(0, seg, src)
def _pad(x, pw):
    flat = tuple(v for pair in reversed(pw) for v in pair)
    return torch.nn.functional.pad(x, flat)

kernel_name = 'concat_heads__gqa_block_cached__gqa_block_cached__near_ridge'

def setup_inputs():

    _w = (lambda a: (lambda t: t.to(torch.bfloat16) if t.is_floating_point() else t)(torch.as_tensor(a)))
    def _A_setup():
        B, Sq, D = 16, 32, 1024
        Hq, Hkv, Sk, Dh = 32, 4, 32, 128
        assert Hq % Hkv == 0, (Hq, Hkv)
        return {
            "x": _w((lambda *s: torch.randn(*s, dtype=torch.bfloat16) * 0.8)(B, Sq, D)),
            "k_cache": _w((lambda *s: torch.randn(*s, dtype=torch.bfloat16) * 0.8)(B, Hkv, Sk, Dh)),
            "v_cache": _w((lambda *s: torch.randn(*s, dtype=torch.bfloat16) * 0.05)(B, Hkv, Sk, Dh)),
            "wq": _w((lambda *s: torch.randn(*s, dtype=torch.bfloat16) * 0.8)(D, Hq * Dh) * (D ** -0.5)),
            "wo": _w((lambda *s: torch.randn(*s, dtype=torch.bfloat16) * 0.05)(Hq * Dh, D) * ((Hq * Dh) ** -0.5)),
        }
    _A_in = _A_setup()

    def _B_setup():
        B, Sq, D = 16, 32, 1024
        Hq, Hkv, Sk, Dh = 32, 4, 32, 128
        assert Hq % Hkv == 0, (Hq, Hkv)
        return {
            "x": _w((lambda *s: torch.randn(*s, dtype=torch.bfloat16) * 0.8)(B, Sq, D)),
            "k_cache": _w((lambda *s: torch.randn(*s, dtype=torch.bfloat16) * 0.8)(B, Hkv, Sk, Dh)),
            "v_cache": _w((lambda *s: torch.randn(*s, dtype=torch.bfloat16) * 0.05)(B, Hkv, Sk, Dh)),
            "wq": _w((lambda *s: torch.randn(*s, dtype=torch.bfloat16) * 0.8)(D, Hq * Dh) * (D ** -0.5)),
            "wo": _w((lambda *s: torch.randn(*s, dtype=torch.bfloat16) * 0.05)(Hq * Dh, D) * ((Hq * Dh) ** -0.5)),
        }
    _B_in = _B_setup()

    return {
        "A_x": _A_in["x"],
        "A_k_cache": _A_in["k_cache"],
        "A_v_cache": _A_in["v_cache"],
        "A_wq": _A_in["wq"],
        "A_wo": _A_in["wo"],
        "B_x": _B_in["x"],
        "B_k_cache": _B_in["k_cache"],
        "B_v_cache": _B_in["v_cache"],
        "B_wq": _B_in["wq"],
        "B_wo": _B_in["wo"],
    }

def reference(A_x, A_k_cache, A_v_cache, A_wq, A_wo, B_x, B_k_cache, B_v_cache, B_wq, B_wo):
    def _A_ref(x, k_cache, v_cache, wq, wo):
        B, Sq, D = x.shape
        Hq, Dh = 32, 128
        Hkv = k_cache.shape[1]
        rep = Hq // Hkv
        q = (lambda x, *d: x.permute(*d))((x @ wq).reshape(B, Sq, Hq, Dh), 0, 2, 1, 3)
        k = (lambda x, n, axis: torch.repeat_interleave(x, n, dim=axis))(k_cache, rep, axis=1)
        v = (lambda x, n, axis: torch.repeat_interleave(x, n, dim=axis))(v_cache, rep, axis=1)
        scores = torch.einsum("bhqd,bhkd->bhqk", q, k) * (Dh ** -0.5)
        p = _softmax(scores, axis=-1)
        o = torch.einsum("bhqk,bhkd->bhqd", p, v)
        return (lambda x, *d: x.permute(*d))(o, 0, 2, 1, 3).reshape(B, Sq, Hq * Dh) @ wo

    def _B_ref(x, k_cache, v_cache, wq, wo):
        B, Sq, D = x.shape
        Hq, Dh = 32, 128
        Hkv = k_cache.shape[1]
        rep = Hq // Hkv
        q = (lambda x, *d: x.permute(*d))((x @ wq).reshape(B, Sq, Hq, Dh), 0, 2, 1, 3)
        k = (lambda x, n, axis: torch.repeat_interleave(x, n, dim=axis))(k_cache, rep, axis=1)
        v = (lambda x, n, axis: torch.repeat_interleave(x, n, dim=axis))(v_cache, rep, axis=1)
        scores = torch.einsum("bhqd,bhkd->bhqk", q, k) * (Dh ** -0.5)
        p = _softmax(scores, axis=-1)
        o = torch.einsum("bhqk,bhkd->bhqd", p, v)
        return (lambda x, *d: x.permute(*d))(o, 0, 2, 1, 3).reshape(B, Sq, Hq * Dh) @ wo

    a = _A_ref(A_x, A_k_cache, A_v_cache, A_wq, A_wo)
    b = _B_ref(B_x, B_k_cache, B_v_cache, B_wq, B_wo)
    return torch.concatenate([a, b], axis=-1)
```

```asm
; @launch grid=(256,1,1) block=(256,1,1) lds=163840
.amdgcn_target "amdgcn-amd-amdhsa--gfx950"
.text
.globl concat_heads__gqa_block_cached__gqa_block_cached__near_ridge_kernel
.p2align 8
.type concat_heads__gqa_block_cached__gqa_block_cached__near_ridge_kernel,@function
concat_heads__gqa_block_cached__gqa_block_cached__near_ridge_kernel:
s_cmp_ge_u32 s2, 256
s_cbranch_scc1 L_end
s_bfe_u32 s5, s2, 0x10002
s_mul_i32 s7, s5, 40
s_add_u32 s92, s0, s7
s_addc_u32 s93, s1, 0
s_load_dwordx2 s[8:9], s[92:93], 0
s_load_dwordx2 s[12:13], s[92:93], 24
s_load_dwordx2 s[16:17], s[92:93], 32
s_load_dwordx2 s[20:21], s[92:93], 8
s_load_dwordx2 s[24:25], s[92:93], 16
s_load_dwordx2 s[28:29], s[0:1], 80
s_load_dwordx2 s[32:33], s[0:1], 88
s_load_dwordx2 s[36:37], s[0:1], 96
s_memrealtime s[90:91]
v_lshrrev_b32 v1, 6, v0
v_and_b32 v0, 63, v0
v_readfirstlane_b32 s6, v1
s_and_b32 s3, s2, 3
s_lshr_b32 s4, s2, 3
s_mov_b32 s10, 0x100000
s_mov_b32 s11, 0x20000
s_mov_b32 s14, 0x800000
s_mov_b32 s15, 0x20000
s_mov_b32 s18, 0x800000
s_mov_b32 s19, 0x20000
s_mov_b32 s22, 0x80000
s_mov_b32 s23, 0x20000
s_mov_b32 s26, 0x80000
s_mov_b32 s27, 0x20000
s_mov_b32 s30, 0x200000
s_mov_b32 s31, 0x20000
s_mov_b32 s34, 0x100
s_mov_b32 s35, 0x20000
s_mov_b32 s38, 0x10000000
s_mov_b32 s39, 0x20000
s_and_b32 s40, s4, 3
s_lshr_b32 s44, s4, 2
s_lshl_b32 s41, s3, 3
s_add_u32 s41, s41, s44
s_lshl_b32 s42, s40, 2
s_add_u32 s42, s42, s6
v_lshrrev_b32 v1, 3, v0
v_lshrrev_b32 v6, 4, v0
v_and_b32 v7, 7, v0
v_xor_b32 v7, v7, v6
v_lshlrev_b32 v7, 4, v7
v_lshl_add_u32 v2, v1, 11, v7
s_lshl_b32 s7, s42, 16
v_add_u32 v2, s7, v2
v_xor_b32 v3, 64, v2
v_add_u32 v5, 0xb400, v3
v_add_u32 v3, 0x3c00, v3
v_add_u32 v4, 0x7800, v2
v_lshlrev_b32 v1, 2, v6
v_and_b32 v7, 15, v0
v_xor_b32 v7, v7, v1
v_lshlrev_b32 v7, 4, v7
v_lshl_add_u32 v6, v6, 13, v7
s_lshl_b32 s7, s6, 17
s_lshl_b32 s45, s41, 8
s_add_u32 s7, s7, s45
v_add_u32 v6, s7, v6
v_add_u32 v7, 0x7c00, v6
v_xor_b32 v9, 32, v6
v_add_u32 v8, 0xf800, v9
v_add_u32 v9, 0x17400, v9
s_add_u32 s46, s40, s44
s_and_b32 s46, s46, 3
s_lshl_b32 s47, s6, 12
s_lshl_b32 s48, s6, 13
s_waitcnt lgkmcnt(0)
s_add_u32 m0, s47, 0x4000
s_or_b32 s49, s46, 0
s_lshl_b32 s50, s49, 19
buffer_load_dwordx4 v6, s[12:15], s50 offen offset:0 lds
buffer_load_dwordx4 v7, s[12:15], s50 offen offset:1024 lds
buffer_load_dwordx4 v8, s[12:15], s50 offen offset:2048 lds
buffer_load_dwordx4 v9, s[12:15], s50 offen offset:3072 lds
s_add_u32 m0, s47, 0x0
s_lshl_b32 s49, s49, 7
s_add_u32 s46, s46, 1
s_and_b32 s46, s46, 3
buffer_load_dwordx4 v2, s[8:11], s49 offen offset:0 lds
buffer_load_dwordx4 v3, s[8:11], s49 offen offset:1024 lds
buffer_load_dwordx4 v4, s[8:11], s49 offen offset:2048 lds
buffer_load_dwordx4 v5, s[8:11], s49 offen offset:3072 lds
v_mov_b32 v53, 0
s_or_b32 s7, s2, s6
s_cmp_lg_u32 s7, 0
s_cbranch_scc1 L_nonon
s_or_b32 s90, s90, 1
v_mov_b32 v54, s90
s_mov_b64 exec, 1
buffer_store_dword v54, v53, s[32:35], 0 offen sc1
s_mov_b64 exec, -1
L_nonon:
s_lshl_b32 s80, s4, 2
s_add_u32 s80, s80, s6
v_and_b32 v49, 31, v0
v_lshlrev_b32 v49, 7, v49
s_lshl_b32 s86, s80, 12
v_and_b32 v50, 7, v0
v_lshlrev_b32 v50, 7, v50
s_lshr_b32 s87, s80, 3
s_lshl_b32 s87, s87, 2
s_add_u32 s87, s87, s3
s_lshl_b32 s87, s87, 3
s_and_b32 s7, s80, 7
s_add_u32 s87, s87, s7
s_lshl_b32 s87, s87, 10
buffer_load_dword v51, v50, s[20:23], s87 offen
s_add_u32 m0, s47, 0xc000
s_or_b32 s49, s46, 0
s_lshl_b32 s50, s49, 19
buffer_load_dwordx4 v6, s[12:15], s50 offen offset:0 lds
buffer_load_dwordx4 v7, s[12:15], s50 offen offset:1024 lds
buffer_load_dwordx4 v8, s[12:15], s50 offen offset:2048 lds
buffer_load_dwordx4 v9, s[12:15], s50 offen offset:3072 lds
s_add_u32 m0, s47, 0x8000
s_lshl_b32 s49, s49, 7
s_add_u32 s46, s46, 1
s_and_b32 s46, s46, 3
buffer_load_dwordx4 v2, s[8:11], s49 offen offset:0 lds
buffer_load_dwordx4 v3, s[8:11], s49 offen offset:1024 lds
buffer_load_dwordx4 v4, s[8:11], s49 offen offset:2048 lds
buffer_load_dwordx4 v5, s[8:11], s49 offen offset:3072 lds
v_lshrrev_b32 v25, 4, v0
v_lshlrev_b32 v25, 21, v25
v_bfe_u32 v41, v0, 2, 2
v_lshl_add_u32 v25, v41, 11, v25
v_and_b32 v41, 3, v0
v_lshl_add_u32 v25, v41, 7, v25
s_lshl_b32 s84, s80, 13
s_lshl_b32 s7, s3, 9
s_add_u32 s84, s84, s7
s_add_u32 s85, s84, 0x100000
s_lshr_b32 s88, s4, 0
s_and_b32 s88, s88, 7
s_lshr_b32 s89, s4, 0
s_and_b32 s89, s89, 7
v_bfe_u32 v46, v0, 4, 1
v_lshlrev_b32 v46, 13, v46
v_and_b32 v47, 15, v0
v_lshl_add_u32 v46, v47, 7, v46
v_lshlrev_b32 v47, 11, v47
s_lshl_b32 s7, s4, 14
s_lshl_b32 s94, s3, 11
s_add_u32 s7, s7, s94
v_add_u32 v46, s7, v46
s_lshl_b32 s7, s4, 15
v_add_u32 v47, s7, v47
s_lshl_b32 s43, s3, 2
s_add_u32 s43, s43, s40
v_lshrrev_b32 v1, 4, v0
v_and_b32 v10, 15, v0
v_xor_b32 v10, v10, v1
v_lshlrev_b32 v10, 4, v10
v_lshl_add_u32 v10, v1, 8, v10
v_xor_b32 v11, 64, v10
v_xor_b32 v12, 128, v10
v_xor_b32 v13, 192, v10
s_lshl_b32 s52, s42, 2
s_add_u32 s52, s52, s3
s_lshl_b32 s52, s52, 13
s_lshr_b32 s81, s6, 1
s_lshl_b32 s53, s44, 3
s_add_u32 s53, s53, s6
s_lshl_b32 s53, s53, 13
s_lshl_b32 s7, s81, 15
s_add_u32 s53, s53, s7
s_xor_b32 s54, s53, 0x8000
v_and_b32 v1, 31, v0
v_lshrrev_b32 v42, 5, v0
v_bfe_u32 v14, v0, 1, 3
v_xor_b32 v14, v14, v42
v_lshlrev_b32 v14, 4, v14
v_lshl_add_u32 v14, v1, 7, v14
v_add_u32 v14, s47, v14
v_lshrrev_b32 v45, 4, v0
v_bfe_u32 v14, v0, 1, 3
v_xor_b32 v14, v14, v45
v_lshlrev_b32 v14, 4, v14
v_and_b32 v45, 15, v0
v_lshl_add_u32 v14, v45, 7, v14
v_add_u32 v14, s47, v14
v_xor_b32 v15, 32, v14
v_xor_b32 v16, 64, v14
v_xor_b32 v17, 96, v14
v_bfe_u32 v43, v0, 2, 2
v_lshl_add_u32 v18, v42, 3, v43
v_lshlrev_b32 v18, 8, v18
v_lshl_add_u32 v18, v43, 6, v18
v_bfe_u32 v44, v0, 4, 1
v_lshl_add_u32 v18, v44, 5, v18
v_and_b32 v45, 1, v0
v_lshl_add_u32 v18, v45, 4, v18
v_bfe_u32 v45, v0, 1, 1
v_lshl_add_u32 v18, v45, 3, v18
v_add_u32 v18, 0x4000, v18
v_lshrrev_b32 v45, 4, v0
v_lshl_add_u32 v18, v45, 3, v43
v_lshlrev_b32 v18, 8, v18
v_lshl_add_u32 v18, v43, 6, v18
v_lshl_add_u32 v18, v44, 5, v18
v_and_b32 v45, 3, v0
v_lshl_add_u32 v18, v45, 3, v18
v_add_u32 v18, 0x4000, v18
v_xor_b32 v64, 32, v18
v_add_u32 v68, 0x10000, v64
v_xor_b32 v65, 96, v18
v_add_u32 v69, 0x10000, v65
v_xor_b32 v66, 160, v18
v_add_u32 v70, 0x10000, v66
v_xor_b32 v67, 224, v18
v_add_u32 v71, 0x10000, v67
v_xor_b32 v19, 64, v18
v_xor_b32 v20, 128, v18
v_xor_b32 v21, 192, v18
v_add_u32 v32, 0x10000, v14
v_add_u32 v33, 0x10000, v15
v_add_u32 v34, 0x10000, v16
v_add_u32 v35, 0x10000, v17
v_add_u32 v36, 0x10000, v18
v_add_u32 v37, 0x10000, v19
v_add_u32 v38, 0x10000, v20
v_add_u32 v39, 0x10000, v21
v_lshrrev_b32 v45, 4, v0
v_lshl_add_u32 v26, v45, 3, v43
v_lshlrev_b32 v26, 7, v26
v_lshrrev_b32 v45, 1, v43
v_lshl_add_u32 v26, v45, 6, v26
v_lshl_add_u32 v26, v44, 5, v26
v_and_b32 v45, 3, v0
v_lshl_add_u32 v26, v45, 3, v26
v_add_u32 v26, s48, v26
s_and_b32 s7, s6, 1
s_lshl_b32 s7, s7, 6
v_xor_b32 v26, s7, v26
v_xor_b32 v27, 64, v26
v_and_b32 v45, 15, v0
v_xor_b32 v45, v45, v42
v_lshlrev_b32 v45, 4, v45
v_lshl_add_u32 v28, v1, 8, v45
v_add_u32 v28, s48, v28
v_add_u32 v24, 0x20000, v28
v_and_b32 v28, 3, v0
v_bfe_u32 v45, v0, 2, 1
v_lshl_add_u32 v28, v45, 3, v28
v_bfe_u32 v45, v0, 3, 1
v_lshl_add_u32 v28, v45, 2, v28
v_lshrrev_b32 v45, 4, v0
v_xor_b32 v45, v45, v28
v_lshlrev_b32 v45, 4, v45
v_lshl_add_u32 v28, v28, 8, v45
v_add_u32 v28, s48, v28
v_lshrrev_b32 v45, 3, v0
v_lshlrev_b32 v30, 2, v44
v_and_b32 v29, 7, v0
v_xor_b32 v30, v30, v29
v_lshlrev_b32 v30, 4, v30
v_lshl_add_u32 v30, v45, 11, v30
s_lshl_b32 s7, s43, 7
s_lshl_b32 s45, s6, 21
s_add_u32 s7, s7, s45
v_add_u32 v30, s7, v30
v_lshlrev_b32 v31, 4, v0
s_mov_b32 s55, s40
s_lshl_b32 s56, s55, 1
s_waitcnt vmcnt(9)
s_barrier
ds_read_b128 a[0:3], v14 offset:0
ds_read_b128 a[4:7], v14 offset:2048
s_add_u32 m0, s47, 0x14000
s_or_b32 s49, s46, 0
s_lshl_b32 s50, s49, 19
buffer_load_dwordx4 v6, s[12:15], s50 offen offset:0 lds
ds_read_b64_tr_b16 a[8:9], v18 offset:0
ds_read_b64_tr_b16 a[10:11], v18 offset:1024
ds_read_b64_tr_b16 a[12:13], v64 offset:0
ds_read_b64_tr_b16 a[14:15], v64 offset:1024
ds_read_b64_tr_b16 a[16:17], v19 offset:0
buffer_load_dwordx4 v7, s[12:15], s50 offen offset:1024 lds
ds_read_b64_tr_b16 a[18:19], v19 offset:1024
ds_read_b64_tr_b16 a[20:21], v65 offset:0
ds_read_b64_tr_b16 a[22:23], v65 offset:1024
ds_read_b64_tr_b16 a[24:25], v20 offset:0
buffer_load_dwordx4 v8, s[12:15], s50 offen offset:2048 lds
ds_read_b64_tr_b16 a[26:27], v20 offset:1024
ds_read_b64_tr_b16 a[28:29], v66 offset:0
ds_read_b64_tr_b16 a[30:31], v66 offset:1024
ds_read_b64_tr_b16 a[32:33], v21 offset:0
ds_read_b64_tr_b16 a[34:35], v21 offset:1024
buffer_load_dwordx4 v9, s[12:15], s50 offen offset:3072 lds
ds_read_b64_tr_b16 a[36:37], v67 offset:0
ds_read_b64_tr_b16 a[38:39], v67 offset:1024
ds_read_b128 a[40:43], v16 offset:0
ds_read_b128 a[44:47], v16 offset:2048
s_add_u32 m0, s47, 0x10000
s_lshl_b32 s49, s49, 7
s_add_u32 s46, s46, 1
s_and_b32 s46, s46, 3
buffer_load_dwordx4 v2, s[8:11], s49 offen offset:0 lds
ds_read_b64_tr_b16 a[48:49], v18 offset:8192
ds_read_b64_tr_b16 a[50:51], v18 offset:9216
ds_read_b64_tr_b16 a[52:53], v64 offset:8192
ds_read_b64_tr_b16 a[54:55], v64 offset:9216
ds_read_b64_tr_b16 a[56:57], v19 offset:8192
buffer_load_dwordx4 v3, s[8:11], s49 offen offset:1024 lds
ds_read_b64_tr_b16 a[58:59], v19 offset:9216
ds_read_b64_tr_b16 a[60:61], v65 offset:8192
ds_read_b64_tr_b16 a[62:63], v65 offset:9216
ds_read_b64_tr_b16 a[64:65], v20 offset:8192
buffer_load_dwordx4 v4, s[8:11], s49 offen offset:2048 lds
ds_read_b64_tr_b16 a[66:67], v20 offset:9216
ds_read_b64_tr_b16 a[68:69], v66 offset:8192
ds_read_b64_tr_b16 a[70:71], v66 offset:9216
ds_read_b64_tr_b16 a[72:73], v21 offset:8192
ds_read_b64_tr_b16 a[74:75], v21 offset:9216
buffer_load_dwordx4 v5, s[8:11], s49 offen offset:3072 lds
ds_read_b64_tr_b16 a[76:77], v67 offset:8192
ds_read_b64_tr_b16 a[78:79], v67 offset:9216
s_waitcnt lgkmcnt(0)
s_waitcnt vmcnt(8)
s_barrier
v_mfma_f32_16x16x32_bf16 v[128:131], a[8:11], a[0:3], 0
s_add_u32 m0, s47, 0x1c000
s_or_b32 s49, s46, 0
s_lshl_b32 s50, s49, 19
buffer_load_dwordx4 v6, s[12:15], s50 offen offset:0 lds
ds_read_b128 a[80:83], v14 offset:32768
ds_read_b128 a[84:87], v14 offset:34816
v_mfma_f32_16x16x32_bf16 v[132:135], a[8:11], a[4:7], 0
ds_read_b64_tr_b16 a[88:89], v18 offset:32768
v_mfma_f32_16x16x32_bf16 v[136:139], a[12:15], a[0:3], 0
ds_read_b64_tr_b16 a[90:91], v18 offset:33792
ds_read_b64_tr_b16 a[92:93], v64 offset:32768
v_mfma_f32_16x16x32_bf16 v[140:143], a[12:15], a[4:7], 0
ds_read_b64_tr_b16 a[94:95], v64 offset:33792
v_mfma_f32_16x16x32_bf16 v[144:147], a[16:19], a[0:3], 0
buffer_load_dwordx4 v7, s[12:15], s50 offen offset:1024 lds
ds_read_b64_tr_b16 a[96:97], v19 offset:32768
ds_read_b64_tr_b16 a[98:99], v19 offset:33792
v_mfma_f32_16x16x32_bf16 v[148:151], a[16:19], a[4:7], 0
ds_read_b64_tr_b16 a[100:101], v65 offset:32768
v_mfma_f32_16x16x32_bf16 v[152:155], a[20:23], a[0:3], 0
ds_read_b64_tr_b16 a[102:103], v65 offset:33792
ds_read_b64_tr_b16 a[104:105], v20 offset:32768
v_mfma_f32_16x16x32_bf16 v[156:159], a[20:23], a[4:7], 0
ds_read_b64_tr_b16 a[106:107], v20 offset:33792
v_mfma_f32_16x16x32_bf16 v[160:163], a[24:27], a[0:3], 0
buffer_load_dwordx4 v8, s[12:15], s50 offen offset:2048 lds
ds_read_b64_tr_b16 a[108:109], v66 offset:32768
ds_read_b64_tr_b16 a[110:111], v66 offset:33792
v_mfma_f32_16x16x32_bf16 v[164:167], a[24:27], a[4:7], 0
ds_read_b64_tr_b16 a[112:113], v21 offset:32768
v_mfma_f32_16x16x32_bf16 v[168:171], a[28:31], a[0:3], 0
ds_read_b64_tr_b16 a[114:115], v21 offset:33792
ds_read_b64_tr_b16 a[116:117], v67 offset:32768
v_mfma_f32_16x16x32_bf16 v[172:175], a[28:31], a[4:7], 0
ds_read_b64_tr_b16 a[118:119], v67 offset:33792
v_mfma_f32_16x16x32_bf16 v[176:179], a[32:35], a[0:3], 0
buffer_load_dwordx4 v9, s[12:15], s50 offen offset:3072 lds
ds_read_b128 a[120:123], v16 offset:32768
ds_read_b128 a[124:127], v16 offset:34816
v_mfma_f32_16x16x32_bf16 v[180:183], a[32:35], a[4:7], 0
ds_read_b64_tr_b16 a[128:129], v18 offset:40960
v_mfma_f32_16x16x32_bf16 v[184:187], a[36:39], a[0:3], 0
ds_read_b64_tr_b16 a[130:131], v18 offset:41984
ds_read_b64_tr_b16 a[132:133], v64 offset:40960
v_mfma_f32_16x16x32_bf16 v[188:191], a[36:39], a[4:7], 0
ds_read_b64_tr_b16 a[134:135], v64 offset:41984
v_mfma_f32_16x16x32_bf16 v[128:131], a[48:51], a[40:43], v[128:131]
s_add_u32 m0, s47, 0x18000
s_lshl_b32 s49, s49, 7
s_add_u32 s46, s46, 1
s_and_b32 s46, s46, 3
buffer_load_dwordx4 v2, s[8:11], s49 offen offset:0 lds
ds_read_b64_tr_b16 a[136:137], v19 offset:40960
ds_read_b64_tr_b16 a[138:139], v19 offset:41984
v_mfma_f32_16x16x32_bf16 v[132:135], a[48:51], a[44:47], v[132:135]
ds_read_b64_tr_b16 a[140:141], v65 offset:40960
v_mfma_f32_16x16x32_bf16 v[136:139], a[52:55], a[40:43], v[136:139]
ds_read_b64_tr_b16 a[142:143], v65 offset:41984
ds_read_b64_tr_b16 a[144:145], v20 offset:40960
v_mfma_f32_16x16x32_bf16 v[140:143], a[52:55], a[44:47], v[140:143]
ds_read_b64_tr_b16 a[146:147], v20 offset:41984
v_mfma_f32_16x16x32_bf16 v[144:147], a[56:59], a[40:43], v[144:147]
buffer_load_dwordx4 v3, s[8:11], s49 offen offset:1024 lds
ds_read_b64_tr_b16 a[148:149], v66 offset:40960
ds_read_b64_tr_b16 a[150:151], v66 offset:41984
v_mfma_f32_16x16x32_bf16 v[148:151], a[56:59], a[44:47], v[148:151]
ds_read_b64_tr_b16 a[152:153], v21 offset:40960
v_mfma_f32_16x16x32_bf16 v[152:155], a[60:63], a[40:43], v[152:155]
ds_read_b64_tr_b16 a[154:155], v21 offset:41984
ds_read_b64_tr_b16 a[156:157], v67 offset:40960
v_mfma_f32_16x16x32_bf16 v[156:159], a[60:63], a[44:47], v[156:159]
ds_read_b64_tr_b16 a[158:159], v67 offset:41984
v_mfma_f32_16x16x32_bf16 v[160:163], a[64:67], a[40:43], v[160:163]
buffer_load_dwordx4 v4, s[8:11], s49 offen offset:2048 lds
v_mfma_f32_16x16x32_bf16 v[164:167], a[64:67], a[44:47], v[164:167]
v_mfma_f32_16x16x32_bf16 v[168:171], a[68:71], a[40:43], v[168:171]
v_mfma_f32_16x16x32_bf16 v[172:175], a[68:71], a[44:47], v[172:175]
v_mfma_f32_16x16x32_bf16 v[176:179], a[72:75], a[40:43], v[176:179]
buffer_load_dwordx4 v5, s[8:11], s49 offen offset:3072 lds
v_mfma_f32_16x16x32_bf16 v[180:183], a[72:75], a[44:47], v[180:183]
v_mfma_f32_16x16x32_bf16 v[184:187], a[76:79], a[40:43], v[184:187]
v_mfma_f32_16x16x32_bf16 v[188:191], a[76:79], a[44:47], v[188:191]
s_waitcnt lgkmcnt(0)
s_waitcnt vmcnt(8)
s_barrier
v_mfma_f32_16x16x32_bf16 v[128:131], a[88:91], a[80:83], v[128:131]
buffer_load_dword v54, v53, s[32:35], 0 offen
ds_read_b128 a[0:3], v32 offset:0
ds_read_b128 a[4:7], v32 offset:2048
v_mfma_f32_16x16x32_bf16 v[132:135], a[88:91], a[84:87], v[132:135]
ds_read_b64_tr_b16 a[8:9], v36 offset:0
v_mfma_f32_16x16x32_bf16 v[136:139], a[92:95], a[80:83], v[136:139]
ds_read_b64_tr_b16 a[10:11], v36 offset:1024
ds_read_b64_tr_b16 a[12:13], v68 offset:0
v_mfma_f32_16x16x32_bf16 v[140:143], a[92:95], a[84:87], v[140:143]
s_add_u32 m0, s47, 0x4000
s_or_b32 s49, s46, 4
s_lshl_b32 s50, s49, 19
buffer_load_dwordx4 v6, s[12:15], s50 offen offset:0 lds
ds_read_b64_tr_b16 a[14:15], v68 offset:1024
v_mfma_f32_16x16x32_bf16 v[144:147], a[96:99], a[80:83], v[144:147]
ds_read_b64_tr_b16 a[16:17], v37 offset:0
ds_read_b64_tr_b16 a[18:19], v37 offset:1024
v_mfma_f32_16x16x32_bf16 v[148:151], a[96:99], a[84:87], v[148:151]
ds_read_b64_tr_b16 a[20:21], v69 offset:0
v_mfma_f32_16x16x32_bf16 v[152:155], a[100:103], a[80:83], v[152:155]
buffer_load_dwordx4 v7, s[12:15], s50 offen offset:1024 lds
ds_read_b64_tr_b16 a[22:23], v69 offset:1024
ds_read_b64_tr_b16 a[24:25], v38 offset:0
v_mfma_f32_16x16x32_bf16 v[156:159], a[100:103], a[84:87], v[156:159]
ds_read_b64_tr_b16 a[26:27], v38 offset:1024
v_mfma_f32_16x16x32_bf16 v[160:163], a[104:107], a[80:83], v[160:163]
ds_read_b64_tr_b16 a[28:29], v70 offset:0
ds_read_b64_tr_b16 a[30:31], v70 offset:1024
v_mfma_f32_16x16x32_bf16 v[164:167], a[104:107], a[84:87], v[164:167]
buffer_load_dwordx4 v8, s[12:15], s50 offen offset:2048 lds
ds_read_b64_tr_b16 a[32:33], v39 offset:0
v_mfma_f32_16x16x32_bf16 v[168:171], a[108:111], a[80:83], v[168:171]
ds_read_b64_tr_b16 a[34:35], v39 offset:1024
ds_read_b64_tr_b16 a[36:37], v71 offset:0
v_mfma_f32_16x16x32_bf16 v[172:175], a[108:111], a[84:87], v[172:175]
ds_read_b64_tr_b16 a[38:39], v71 offset:1024
v_mfma_f32_16x16x32_bf16 v[176:179], a[112:115], a[80:83], v[176:179]
buffer_load_dwordx4 v9, s[12:15], s50 offen offset:3072 lds
ds_read_b128 a[40:43], v34 offset:0
ds_read_b128 a[44:47], v34 offset:2048
v_mfma_f32_16x16x32_bf16 v[180:183], a[112:115], a[84:87], v[180:183]
ds_read_b64_tr_b16 a[48:49], v36 offset:8192
v_mfma_f32_16x16x32_bf16 v[184:187], a[116:119], a[80:83], v[184:187]
ds_read_b64_tr_b16 a[50:51], v36 offset:9216
ds_read_b64_tr_b16 a[52:53], v68 offset:8192
v_mfma_f32_16x16x32_bf16 v[188:191], a[116:119], a[84:87], v[188:191]
ds_read_b64_tr_b16 a[54:55], v68 offset:9216
v_mfma_f32_16x16x32_bf16 v[128:131], a[128:131], a[120:123], v[128:131]
s_add_u32 m0, s47, 0x0
s_lshl_b32 s49, s49, 7
s_add_u32 s46, s46, 1
s_and_b32 s46, s46, 3
buffer_load_dwordx4 v2, s[8:11], s49 offen offset:0 lds
ds_read_b64_tr_b16 a[56:57], v37 offset:8192
ds_read_b64_tr_b16 a[58:59], v37 offset:9216
v_mfma_f32_16x16x32_bf16 v[132:135], a[128:131], a[124:127], v[132:135]
ds_read_b64_tr_b16 a[60:61], v69 offset:8192
v_mfma_f32_16x16x32_bf16 v[136:139], a[132:135], a[120:123], v[136:139]
ds_read_b64_tr_b16 a[62:63], v69 offset:9216
ds_read_b64_tr_b16 a[64:65], v38 offset:8192
v_mfma_f32_16x16x32_bf16 v[140:143], a[132:135], a[124:127], v[140:143]
buffer_load_dwordx4 v3, s[8:11], s49 offen offset:1024 lds
ds_read_b64_tr_b16 a[66:67], v38 offset:9216
v_mfma_f32_16x16x32_bf16 v[144:147], a[136:139], a[120:123], v[144:147]
ds_read_b64_tr_b16 a[68:69], v70 offset:8192
ds_read_b64_tr_b16 a[70:71], v70 offset:9216
v_mfma_f32_16x16x32_bf16 v[148:151], a[136:139], a[124:127], v[148:151]
ds_read_b64_tr_b16 a[72:73], v39 offset:8192
v_mfma_f32_16x16x32_bf16 v[152:155], a[140:143], a[120:123], v[152:155]
buffer_load_dwordx4 v4, s[8:11], s49 offen offset:2048 lds
ds_read_b64_tr_b16 a[74:75], v39 offset:9216
ds_read_b64_tr_b16 a[76:77], v71 offset:8192
v_mfma_f32_16x16x32_bf16 v[156:159], a[140:143], a[124:127], v[156:159]
ds_read_b64_tr_b16 a[78:79], v71 offset:9216
v_mfma_f32_16x16x32_bf16 v[160:163], a[144:147], a[120:123], v[160:163]
v_mfma_f32_16x16x32_bf16 v[164:167], a[144:147], a[124:127], v[164:167]
buffer_load_dwordx4 v5, s[8:11], s49 offen offset:3072 lds
v_mfma_f32_16x16x32_bf16 v[168:171], a[148:151], a[120:123], v[168:171]
v_mfma_f32_16x16x32_bf16 v[172:175], a[148:151], a[124:127], v[172:175]
v_mfma_f32_16x16x32_bf16 v[176:179], a[152:155], a[120:123], v[176:179]
buffer_load_dword v52, v49, s[24:27], s86 offen
v_mfma_f32_16x16x32_bf16 v[180:183], a[152:155], a[124:127], v[180:183]
v_mfma_f32_16x16x32_bf16 v[184:187], a[156:159], a[120:123], v[184:187]
v_mfma_f32_16x16x32_bf16 v[188:191], a[156:159], a[124:127], v[188:191]
s_waitcnt lgkmcnt(0)
s_waitcnt vmcnt(10)
s_barrier
v_mfma_f32_16x16x32_bf16 v[128:131], a[8:11], a[0:3], v[128:131]
s_add_u32 m0, s47, 0xc000
s_or_b32 s49, s46, 4
s_lshl_b32 s50, s49, 19
buffer_load_dwordx4 v6, s[12:15], s50 offen offset:0 lds
ds_read_b128 a[80:83], v32 offset:32768
ds_read_b128 a[84:87], v32 offset:34816
v_mfma_f32_16x16x32_bf16 v[132:135], a[8:11], a[4:7], v[132:135]
ds_read_b64_tr_b16 a[88:89], v36 offset:32768
v_mfma_f32_16x16x32_bf16 v[136:139], a[12:15], a[0:3], v[136:139]
ds_read_b64_tr_b16 a[90:91], v36 offset:33792
ds_read_b64_tr_b16 a[92:93], v68 offset:32768
v_mfma_f32_16x16x32_bf16 v[140:143], a[12:15], a[4:7], v[140:143]
ds_read_b64_tr_b16 a[94:95], v68 offset:33792
v_mfma_f32_16x16x32_bf16 v[144:147], a[16:19], a[0:3], v[144:147]
buffer_load_dwordx4 v7, s[12:15], s50 offen offset:1024 lds
ds_read_b64_tr_b16 a[96:97], v37 offset:32768
ds_read_b64_tr_b16 a[98:99], v37 offset:33792
v_mfma_f32_16x16x32_bf16 v[148:151], a[16:19], a[4:7], v[148:151]
ds_read_b64_tr_b16 a[100:101], v69 offset:32768
v_mfma_f32_16x16x32_bf16 v[152:155], a[20:23], a[0:3], v[152:155]
ds_read_b64_tr_b16 a[102:103], v69 offset:33792
ds_read_b64_tr_b16 a[104:105], v38 offset:32768
v_mfma_f32_16x16x32_bf16 v[156:159], a[20:23], a[4:7], v[156:159]
ds_read_b64_tr_b16 a[106:107], v38 offset:33792
v_mfma_f32_16x16x32_bf16 v[160:163], a[24:27], a[0:3], v[160:163]
buffer_load_dwordx4 v8, s[12:15], s50 offen offset:2048 lds
ds_read_b64_tr_b16 a[108:109], v70 offset:32768
ds_read_b64_tr_b16 a[110:111], v70 offset:33792
v_mfma_f32_16x16x32_bf16 v[164:167], a[24:27], a[4:7], v[164:167]
ds_read_b64_tr_b16 a[112:113], v39 offset:32768
v_mfma_f32_16x16x32_bf16 v[168:171], a[28:31], a[0:3], v[168:171]
ds_read_b64_tr_b16 a[114:115], v39 offset:33792
ds_read_b64_tr_b16 a[116:117], v71 offset:32768
v_mfma_f32_16x16x32_bf16 v[172:175], a[28:31], a[4:7], v[172:175]
ds_read_b64_tr_b16 a[118:119], v71 offset:33792
v_mfma_f32_16x16x32_bf16 v[176:179], a[32:35], a[0:3], v[176:179]
buffer_load_dwordx4 v9, s[12:15], s50 offen offset:3072 lds
ds_read_b128 a[120:123], v34 offset:32768
ds_read_b128 a[124:127], v34 offset:34816
v_mfma_f32_16x16x32_bf16 v[180:183], a[32:35], a[4:7], v[180:183]
ds_read_b64_tr_b16 a[128:129], v36 offset:40960
v_mfma_f32_16x16x32_bf16 v[184:187], a[36:39], a[0:3], v[184:187]
ds_read_b64_tr_b16 a[130:131], v36 offset:41984
ds_read_b64_tr_b16 a[132:133], v68 offset:40960
v_mfma_f32_16x16x32_bf16 v[188:191], a[36:39], a[4:7], v[188:191]
ds_read_b64_tr_b16 a[134:135], v68 offset:41984
v_mfma_f32_16x16x32_bf16 v[128:131], a[48:51], a[40:43], v[128:131]
s_add_u32 m0, s47, 0x8000
s_lshl_b32 s49, s49, 7
s_add_u32 s46, s46, 1
s_and_b32 s46, s46, 3
buffer_load_dwordx4 v2, s[8:11], s49 offen offset:0 lds
ds_read_b64_tr_b16 a[136:137], v37 offset:40960
ds_read_b64_tr_b16 a[138:139], v37 offset:41984
v_mfma_f32_16x16x32_bf16 v[132:135], a[48:51], a[44:47], v[132:135]
ds_read_b64_tr_b16 a[140:141], v69 offset:40960
v_mfma_f32_16x16x32_bf16 v[136:139], a[52:55], a[40:43], v[136:139]
ds_read_b64_tr_b16 a[142:143], v69 offset:41984
ds_read_b64_tr_b16 a[144:145], v38 offset:40960
v_mfma_f32_16x16x32_bf16 v[140:143], a[52:55], a[44:47], v[140:143]
ds_read_b64_tr_b16 a[146:147], v38 offset:41984
v_mfma_f32_16x16x32_bf16 v[144:147], a[56:59], a[40:43], v[144:147]
buffer_load_dwordx4 v3, s[8:11], s49 offen offset:1024 lds
ds_read_b64_tr_b16 a[148:149], v70 offset:40960
ds_read_b64_tr_b16 a[150:151], v70 offset:41984
v_mfma_f32_16x16x32_bf16 v[148:151], a[56:59], a[44:47], v[148:151]
ds_read_b64_tr_b16 a[152:153], v39 offset:40960
v_mfma_f32_16x16x32_bf16 v[152:155], a[60:63], a[40:43], v[152:155]
ds_read_b64_tr_b16 a[154:155], v39 offset:41984
ds_read_b64_tr_b16 a[156:157], v71 offset:40960
v_mfma_f32_16x16x32_bf16 v[156:159], a[60:63], a[44:47], v[156:159]
ds_read_b64_tr_b16 a[158:159], v71 offset:41984
v_mfma_f32_16x16x32_bf16 v[160:163], a[64:67], a[40:43], v[160:163]
buffer_load_dwordx4 v4, s[8:11], s49 offen offset:2048 lds
v_mfma_f32_16x16x32_bf16 v[164:167], a[64:67], a[44:47], v[164:167]
v_mfma_f32_16x16x32_bf16 v[168:171], a[68:71], a[40:43], v[168:171]
v_mfma_f32_16x16x32_bf16 v[172:175], a[68:71], a[44:47], v[172:175]
v_mfma_f32_16x16x32_bf16 v[176:179], a[72:75], a[40:43], v[176:179]
buffer_load_dwordx4 v5, s[8:11], s49 offen offset:3072 lds
v_mfma_f32_16x16x32_bf16 v[180:183], a[72:75], a[44:47], v[180:183]
v_mfma_f32_16x16x32_bf16 v[184:187], a[76:79], a[40:43], v[184:187]
v_mfma_f32_16x16x32_bf16 v[188:191], a[76:79], a[44:47], v[188:191]
s_waitcnt lgkmcnt(0)
s_waitcnt vmcnt(9)
s_barrier
v_mfma_f32_16x16x32_bf16 v[128:131], a[88:91], a[80:83], v[128:131]
s_add_u32 m0, s48, 0x20000
s_add_u32 s51, s52, 0
buffer_load_dwordx4 v10, s[20:23], s51 offen offset:0 lds
ds_read_b128 a[0:3], v14 offset:0
ds_read_b128 a[4:7], v14 offset:2048
v_mfma_f32_16x16x32_bf16 v[132:135], a[88:91], a[84:87], v[132:135]
ds_read_b64_tr_b16 a[8:9], v18 offset:0
v_mfma_f32_16x16x32_bf16 v[136:139], a[92:95], a[80:83], v[136:139]
buffer_load_dwordx4 v11, s[20:23], s51 offen offset:1024 lds
ds_read_b64_tr_b16 a[10:11], v18 offset:1024
ds_read_b64_tr_b16 a[12:13], v64 offset:0
v_mfma_f32_16x16x32_bf16 v[140:143], a[92:95], a[84:87], v[140:143]
ds_read_b64_tr_b16 a[14:15], v64 offset:1024
v_mfma_f32_16x16x32_bf16 v[144:147], a[96:99], a[80:83], v[144:147]
buffer_load_dwordx4 v12, s[20:23], s51 offen offset:2048 lds
ds_read_b64_tr_b16 a[16:17], v19 offset:0
ds_read_b64_tr_b16 a[18:19], v19 offset:1024
v_mfma_f32_16x16x32_bf16 v[148:151], a[96:99], a[84:87], v[148:151]
ds_read_b64_tr_b16 a[20:21], v65 offset:0
v_mfma_f32_16x16x32_bf16 v[152:155], a[100:103], a[80:83], v[152:155]
buffer_load_dwordx4 v13, s[20:23], s51 offen offset:3072 lds
ds_read_b64_tr_b16 a[22:23], v65 offset:1024
ds_read_b64_tr_b16 a[24:25], v20 offset:0
v_mfma_f32_16x16x32_bf16 v[156:159], a[100:103], a[84:87], v[156:159]
ds_read_b64_tr_b16 a[26:27], v20 offset:1024
v_mfma_f32_16x16x32_bf16 v[160:163], a[104:107], a[80:83], v[160:163]
s_add_u32 m0, s48, 0x21000
s_add_u32 s51, s52, 4096
buffer_load_dwordx4 v10, s[20:23], s51 offen offset:0 lds
ds_read_b64_tr_b16 a[28:29], v66 offset:0
ds_read_b64_tr_b16 a[30:31], v66 offset:1024
v_mfma_f32_16x16x32_bf16 v[164:167], a[104:107], a[84:87], v[164:167]
ds_read_b64_tr_b16 a[32:33], v21 offset:0
v_mfma_f32_16x16x32_bf16 v[168:171], a[108:111], a[80:83], v[168:171]
buffer_load_dwordx4 v11, s[20:23], s51 offen offset:1024 lds
ds_read_b64_tr_b16 a[34:35], v21 offset:1024
ds_read_b64_tr_b16 a[36:37], v67 offset:0
v_mfma_f32_16x16x32_bf16 v[172:175], a[108:111], a[84:87], v[172:175]
ds_read_b64_tr_b16 a[38:39], v67 offset:1024
v_mfma_f32_16x16x32_bf16 v[176:179], a[112:115], a[80:83], v[176:179]
buffer_load_dwordx4 v12, s[20:23], s51 offen offset:2048 lds
ds_read_b128 a[40:43], v16 offset:0
ds_read_b128 a[44:47], v16 offset:2048
v_mfma_f32_16x16x32_bf16 v[180:183], a[112:115], a[84:87], v[180:183]
ds_read_b64_tr_b16 a[48:49], v18 offset:8192
v_mfma_f32_16x16x32_bf16 v[184:187], a[116:119], a[80:83], v[184:187]
buffer_load_dwordx4 v13, s[20:23], s51 offen offset:3072 lds
ds_read_b64_tr_b16 a[50:51], v18 offset:9216
ds_read_b64_tr_b16 a[52:53], v64 offset:8192
v_mfma_f32_16x16x32_bf16 v[188:191], a[116:119], a[84:87], v[188:191]
ds_read_b64_tr_b16 a[54:55], v64 offset:9216
v_mfma_f32_16x16x32_bf16 v[128:131], a[128:131], a[120:123], v[128:131]
s_add_u32 m0, s47, 0x14000
s_or_b32 s49, s46, 4
s_lshl_b32 s50, s49, 19
buffer_load_dwordx4 v6, s[12:15], s50 offen offset:0 lds
ds_read_b64_tr_b16 a[56:57], v19 offset:8192
ds_read_b64_tr_b16 a[58:59], v19 offset:9216
v_mfma_f32_16x16x32_bf16 v[132:135], a[128:131], a[124:127], v[132:135]
ds_read_b64_tr_b16 a[60:61], v65 offset:8192
v_mfma_f32_16x16x32_bf16 v[136:139], a[132:135], a[120:123], v[136:139]
buffer_load_dwordx4 v7, s[12:15], s50 offen offset:1024 lds
ds_read_b64_tr_b16 a[62:63], v65 offset:9216
ds_read_b64_tr_b16 a[64:65], v20 offset:8192
v_mfma_f32_16x16x32_bf16 v[140:143], a[132:135], a[124:127], v[140:143]
ds_read_b64_tr_b16 a[66:67], v20 offset:9216
v_mfma_f32_16x16x32_bf16 v[144:147], a[136:139], a[120:123], v[144:147]
buffer_load_dwordx4 v8, s[12:15], s50 offen offset:2048 lds
ds_read_b64_tr_b16 a[68:69], v66 offset:8192
ds_read_b64_tr_b16 a[70:71], v66 offset:9216
v_mfma_f32_16x16x32_bf16 v[148:151], a[136:139], a[124:127], v[148:151]
ds_read_b64_tr_b16 a[72:73], v21 offset:8192
v_mfma_f32_16x16x32_bf16 v[152:155], a[140:143], a[120:123], v[152:155]
buffer_load_dwordx4 v9, s[12:15], s50 offen offset:3072 lds
ds_read_b64_tr_b16 a[74:75], v21 offset:9216
ds_read_b64_tr_b16 a[76:77], v67 offset:8192
v_mfma_f32_16x16x32_bf16 v[156:159], a[140:143], a[124:127], v[156:159]
ds_read_b64_tr_b16 a[78:79], v67 offset:9216
v_mfma_f32_16x16x32_bf16 v[160:163], a[144:147], a[120:123], v[160:163]
s_add_u32 m0, s47, 0x10000
s_lshl_b32 s49, s49, 7
s_add_u32 s46, s46, 1
s_and_b32 s46, s46, 3
buffer_load_dwordx4 v2, s[8:11], s49 offen offset:0 lds
v_mfma_f32_16x16x32_bf16 v[164:167], a[144:147], a[124:127], v[164:167]
v_mfma_f32_16x16x32_bf16 v[168:171], a[148:151], a[120:123], v[168:171]
buffer_load_dwordx4 v3, s[8:11], s49 offen offset:1024 lds
v_mfma_f32_16x16x32_bf16 v[172:175], a[148:151], a[124:127], v[172:175]
v_mfma_f32_16x16x32_bf16 v[176:179], a[152:155], a[120:123], v[176:179]
buffer_load_dwordx4 v4, s[8:11], s49 offen offset:2048 lds
v_mfma_f32_16x16x32_bf16 v[180:183], a[152:155], a[124:127], v[180:183]
v_mfma_f32_16x16x32_bf16 v[184:187], a[156:159], a[120:123], v[184:187]
buffer_load_dwordx4 v5, s[8:11], s49 offen offset:3072 lds
v_mfma_f32_16x16x32_bf16 v[188:191], a[156:159], a[124:127], v[188:191]
s_waitcnt lgkmcnt(0)
s_waitcnt vmcnt(16)
s_barrier
v_mfma_f32_16x16x32_bf16 v[128:131], a[8:11], a[0:3], v[128:131]
s_add_u32 m0, s47, 0x1c000
s_or_b32 s49, s46, 4
s_lshl_b32 s50, s49, 19
buffer_load_dwordx4 v6, s[12:15], s50 offen offset:0 lds
ds_read_b128 a[80:83], v14 offset:32768
ds_read_b128 a[84:87], v14 offset:34816
v_mfma_f32_16x16x32_bf16 v[132:135], a[8:11], a[4:7], v[132:135]
ds_read_b64_tr_b16 a[88:89], v18 offset:32768
v_mfma_f32_16x16x32_bf16 v[136:139], a[12:15], a[0:3], v[136:139]
ds_read_b64_tr_b16 a[90:91], v18 offset:33792
ds_read_b64_tr_b16 a[92:93], v64 offset:32768
v_mfma_f32_16x16x32_bf16 v[140:143], a[12:15], a[4:7], v[140:143]
ds_read_b64_tr_b16 a[94:95], v64 offset:33792
v_mfma_f32_16x16x32_bf16 v[144:147], a[16:19], a[0:3], v[144:147]
buffer_load_dwordx4 v7, s[12:15], s50 offen offset:1024 lds
ds_read_b64_tr_b16 a[96:97], v19 offset:32768
ds_read_b64_tr_b16 a[98:99], v19 offset:33792
v_mfma_f32_16x16x32_bf16 v[148:151], a[16:19], a[4:7], v[148:151]
ds_read_b64_tr_b16 a[100:101], v65 offset:32768
v_mfma_f32_16x16x32_bf16 v[152:155], a[20:23], a[0:3], v[152:155]
ds_read_b64_tr_b16 a[102:103], v65 offset:33792
ds_read_b64_tr_b16 a[104:105], v20 offset:32768
v_mfma_f32_16x16x32_bf16 v[156:159], a[20:23], a[4:7], v[156:159]
ds_read_b64_tr_b16 a[106:107], v20 offset:33792
v_mfma_f32_16x16x32_bf16 v[160:163], a[24:27], a[0:3], v[160:163]
buffer_load_dwordx4 v8, s[12:15], s50 offen offset:2048 lds
ds_read_b64_tr_b16 a[108:109], v66 offset:32768
ds_read_b64_tr_b16 a[110:111], v66 offset:33792
v_mfma_f32_16x16x32_bf16 v[164:167], a[24:27], a[4:7], v[164:167]
ds_read_b64_tr_b16 a[112:113], v21 offset:32768
v_mfma_f32_16x16x32_bf16 v[168:171], a[28:31], a[0:3], v[168:171]
ds_read_b64_tr_b16 a[114:115], v21 offset:33792
ds_read_b64_tr_b16 a[116:117], v67 offset:32768
v_mfma_f32_16x16x32_bf16 v[172:175], a[28:31], a[4:7], v[172:175]
ds_read_b64_tr_b16 a[118:119], v67 offset:33792
v_mfma_f32_16x16x32_bf16 v[176:179], a[32:35], a[0:3], v[176:179]
buffer_load_dwordx4 v9, s[12:15], s50 offen offset:3072 lds
ds_read_b128 a[120:123], v16 offset:32768
ds_read_b128 a[124:127], v16 offset:34816
v_mfma_f32_16x16x32_bf16 v[180:183], a[32:35], a[4:7], v[180:183]
ds_read_b64_tr_b16 a[128:129], v18 offset:40960
v_mfma_f32_16x16x32_bf16 v[184:187], a[36:39], a[0:3], v[184:187]
ds_read_b64_tr_b16 a[130:131], v18 offset:41984
ds_read_b64_tr_b16 a[132:133], v64 offset:40960
v_mfma_f32_16x16x32_bf16 v[188:191], a[36:39], a[4:7], v[188:191]
ds_read_b64_tr_b16 a[134:135], v64 offset:41984
v_mfma_f32_16x16x32_bf16 v[128:131], a[48:51], a[40:43], v[128:131]
s_add_u32 m0, s47, 0x18000
s_lshl_b32 s49, s49, 7
s_add_u32 s46, s46, 1
s_and_b32 s46, s46, 3
buffer_load_dwordx4 v2, s[8:11], s49 offen offset:0 lds
ds_read_b64_tr_b16 a[136:137], v19 offset:40960
ds_read_b64_tr_b16 a[138:139], v19 offset:41984
v_mfma_f32_16x16x32_bf16 v[132:135], a[48:51], a[44:47], v[132:135]
ds_read_b64_tr_b16 a[140:141], v65 offset:40960
v_mfma_f32_16x16x32_bf16 v[136:139], a[52:55], a[40:43], v[136:139]
ds_read_b64_tr_b16 a[142:143], v65 offset:41984
ds_read_b64_tr_b16 a[144:145], v20 offset:40960
v_mfma_f32_16x16x32_bf16 v[140:143], a[52:55], a[44:47], v[140:143]
ds_read_b64_tr_b16 a[146:147], v20 offset:41984
v_mfma_f32_16x16x32_bf16 v[144:147], a[56:59], a[40:43], v[144:147]
buffer_load_dwordx4 v3, s[8:11], s49 offen offset:1024 lds
ds_read_b64_tr_b16 a[148:149], v66 offset:40960
ds_read_b64_tr_b16 a[150:151], v66 offset:41984
v_mfma_f32_16x16x32_bf16 v[148:151], a[56:59], a[44:47], v[148:151]
ds_read_b64_tr_b16 a[152:153], v21 offset:40960
v_mfma_f32_16x16x32_bf16 v[152:155], a[60:63], a[40:43], v[152:155]
ds_read_b64_tr_b16 a[154:155], v21 offset:41984
ds_read_b64_tr_b16 a[156:157], v67 offset:40960
v_mfma_f32_16x16x32_bf16 v[156:159], a[60:63], a[44:47], v[156:159]
ds_read_b64_tr_b16 a[158:159], v67 offset:41984
v_mfma_f32_16x16x32_bf16 v[160:163], a[64:67], a[40:43], v[160:163]
buffer_load_dwordx4 v4, s[8:11], s49 offen offset:2048 lds
v_mfma_f32_16x16x32_bf16 v[164:167], a[64:67], a[44:47], v[164:167]
v_mfma_f32_16x16x32_bf16 v[168:171], a[68:71], a[40:43], v[168:171]
v_mfma_f32_16x16x32_bf16 v[172:175], a[68:71], a[44:47], v[172:175]
v_mfma_f32_16x16x32_bf16 v[176:179], a[72:75], a[40:43], v[176:179]
buffer_load_dwordx4 v5, s[8:11], s49 offen offset:3072 lds
v_mfma_f32_16x16x32_bf16 v[180:183], a[72:75], a[44:47], v[180:183]
v_mfma_f32_16x16x32_bf16 v[184:187], a[76:79], a[40:43], v[184:187]
v_mfma_f32_16x16x32_bf16 v[188:191], a[76:79], a[44:47], v[188:191]
s_waitcnt lgkmcnt(0)
s_mov_b32 s45, 0
L_nonce:
v_readfirstlane_b32 s90, v54
s_cmp_lg_u32 s90, 0
s_cbranch_scc1 L_nonced
s_add_u32 s45, s45, 1
s_cmp_ge_u32 s45, 0x200000
s_cbranch_scc1 L_nonced
buffer_load_dword v54, v53, s[32:35], 0 offen sc1
s_waitcnt vmcnt(0)
s_branch L_nonce
L_nonced:
s_waitcnt vmcnt(8)
s_barrier
v_mfma_f32_16x16x32_bf16 v[128:131], a[88:91], a[80:83], v[128:131]
s_add_u32 m0, s47, 0x4000
s_or_b32 s49, s46, 8
s_lshl_b32 s50, s49, 19
buffer_load_dwordx4 v6, s[12:15], s50 offen offset:0 lds
ds_read_b128 a[0:3], v32 offset:0
ds_read_b128 a[4:7], v32 offset:2048
v_mfma_f32_16x16x32_bf16 v[132:135], a[88:91], a[84:87], v[132:135]
ds_read_b64_tr_b16 a[8:9], v36 offset:0
v_mfma_f32_16x16x32_bf16 v[136:139], a[92:95], a[80:83], v[136:139]
ds_read_b64_tr_b16 a[10:11], v36 offset:1024
ds_read_b64_tr_b16 a[12:13], v68 offset:0
v_mfma_f32_16x16x32_bf16 v[140:143], a[92:95], a[84:87], v[140:143]
buffer_load_dwordx4 v7, s[12:15], s50 offen offset:1024 lds
ds_read_b64_tr_b16 a[14:15], v68 offset:1024
v_mfma_f32_16x16x32_bf16 v[144:147], a[96:99], a[80:83], v[144:147]
ds_read_b64_tr_b16 a[16:17], v37 offset:0
ds_read_b64_tr_b16 a[18:19], v37 offset:1024
v_mfma_f32_16x16x32_bf16 v[148:151], a[96:99], a[84:87], v[148:151]
ds_read_b64_tr_b16 a[20:21], v69 offset:0
v_mfma_f32_16x16x32_bf16 v[152:155], a[100:103], a[80:83], v[152:155]
ds_read_b64_tr_b16 a[22:23], v69 offset:1024
ds_read_b64_tr_b16 a[24:25], v38 offset:0
v_mfma_f32_16x16x32_bf16 v[156:159], a[100:103], a[84:87], v[156:159]
buffer_load_dwordx4 v8, s[12:15], s50 offen offset:2048 lds
ds_read_b64_tr_b16 a[26:27], v38 offset:1024
v_mfma_f32_16x16x32_bf16 v[160:163], a[104:107], a[80:83], v[160:163]
ds_read_b64_tr_b16 a[28:29], v70 offset:0
ds_read_b64_tr_b16 a[30:31], v70 offset:1024
v_mfma_f32_16x16x32_bf16 v[164:167], a[104:107], a[84:87], v[164:167]
ds_read_b64_tr_b16 a[32:33], v39 offset:0
v_mfma_f32_16x16x32_bf16 v[168:171], a[108:111], a[80:83], v[168:171]
buffer_load_dwordx4 v9, s[12:15], s50 offen offset:3072 lds
ds_read_b64_tr_b16 a[34:35], v39 offset:1024
ds_read_b64_tr_b16 a[36:37], v71 offset:0
v_mfma_f32_16x16x32_bf16 v[172:175], a[108:111], a[84:87], v[172:175]
ds_read_b64_tr_b16 a[38:39], v71 offset:1024
v_mfma_f32_16x16x32_bf16 v[176:179], a[112:115], a[80:83], v[176:179]
ds_read_b128 a[40:43], v34 offset:0
ds_read_b128 a[44:47], v34 offset:2048
v_mfma_f32_16x16x32_bf16 v[180:183], a[112:115], a[84:87], v[180:183]
ds_read_b64_tr_b16 a[48:49], v36 offset:8192
v_mfma_f32_16x16x32_bf16 v[184:187], a[116:119], a[80:83], v[184:187]
s_add_u32 m0, s47, 0x0
s_lshl_b32 s49, s49, 7
s_add_u32 s46, s46, 1
s_and_b32 s46, s46, 3
buffer_load_dwordx4 v2, s[8:11], s49 offen offset:0 lds
ds_read_b64_tr_b16 a[50:51], v36 offset:9216
ds_read_b64_tr_b16 a[52:53], v68 offset:8192
v_mfma_f32_16x16x32_bf16 v[188:191], a[116:119], a[84:87], v[188:191]
ds_read_b64_tr_b16 a[54:55], v68 offset:9216
v_mfma_f32_16x16x32_bf16 v[128:131], a[128:131], a[120:123], v[128:131]
ds_read_b64_tr_b16 a[56:57], v37 offset:8192
ds_read_b64_tr_b16 a[58:59], v37 offset:9216
v_mfma_f32_16x16x32_bf16 v[132:135], a[128:131], a[124:127], v[132:135]
buffer_load_dwordx4 v3, s[8:11], s49 offen offset:1024 lds
ds_read_b64_tr_b16 a[60:61], v69 offset:8192
v_mfma_f32_16x16x32_bf16 v[136:139], a[132:135], a[120:123], v[136:139]
ds_read_b64_tr_b16 a[62:63], v69 offset:9216
ds_read_b64_tr_b16 a[64:65], v38 offset:8192
v_mfma_f32_16x16x32_bf16 v[140:143], a[132:135], a[124:127], v[140:143]
ds_read_b64_tr_b16 a[66:67], v38 offset:9216
v_mfma_f32_16x16x32_bf16 v[144:147], a[136:139], a[120:123], v[144:147]
ds_read_b64_tr_b16 a[68:69], v70 offset:8192
ds_read_b64_tr_b16 a[70:71], v70 offset:9216
v_mfma_f32_16x16x32_bf16 v[148:151], a[136:139], a[124:127], v[148:151]
buffer_load_dwordx4 v4, s[8:11], s49 offen offset:2048 lds
ds_read_b64_tr_b16 a[72:73], v39 offset:8192
v_mfma_f32_16x16x32_bf16 v[152:155], a[140:143], a[120:123], v[152:155]
ds_read_b64_tr_b16 a[74:75], v39 offset:9216
ds_read_b64_tr_b16 a[76:77], v71 offset:8192
v_mfma_f32_16x16x32_bf16 v[156:159], a[140:143], a[124:127], v[156:159]
ds_read_b64_tr_b16 a[78:79], v71 offset:9216
v_mfma_f32_16x16x32_bf16 v[160:163], a[144:147], a[120:123], v[160:163]
buffer_load_dwordx4 v5, s[8:11], s49 offen offset:3072 lds
v_mfma_f32_16x16x32_bf16 v[164:167], a[144:147], a[124:127], v[164:167]
v_mfma_f32_16x16x32_bf16 v[168:171], a[148:151], a[120:123], v[168:171]
v_mfma_f32_16x16x32_bf16 v[172:175], a[148:151], a[124:127], v[172:175]
v_mfma_f32_16x16x32_bf16 v[176:179], a[152:155], a[120:123], v[176:179]
s_cmp_lg_u32 s88, 0
s_cbranch_scc1 L_pf1
buffer_load_dword v22, v25, s[16:19], s84 offen
L_pf1:
v_mfma_f32_16x16x32_bf16 v[180:183], a[152:155], a[124:127], v[180:183]
v_mfma_f32_16x16x32_bf16 v[184:187], a[156:159], a[120:123], v[184:187]
v_mfma_f32_16x16x32_bf16 v[188:191], a[156:159], a[124:127], v[188:191]
s_waitcnt lgkmcnt(0)
s_waitcnt vmcnt(8)
s_barrier
v_mfma_f32_16x16x32_bf16 v[128:131], a[8:11], a[0:3], v[128:131]
s_add_u32 m0, s47, 0xc000
s_or_b32 s49, s46, 8
s_lshl_b32 s50, s49, 19
buffer_load_dwordx4 v6, s[12:15], s50 offen offset:0 lds
ds_read_b128 a[80:83], v32 offset:32768
ds_read_b128 a[84:87], v32 offset:34816
v_mfma_f32_16x16x32_bf16 v[132:135], a[8:11], a[4:7], v[132:135]
ds_read_b64_tr_b16 a[88:89], v36 offset:32768
ds_read_b64_tr_b16 a[90:91], v36 offset:33792
v_mfma_f32_16x16x32_bf16 v[136:139], a[12:15], a[0:3], v[136:139]
ds_read_b64_tr_b16 a[92:93], v68 offset:32768
ds_read_b64_tr_b16 a[94:95], v68 offset:33792
v_mfma_f32_16x16x32_bf16 v[140:143], a[12:15], a[4:7], v[140:143]
buffer_load_dwordx4 v7, s[12:15], s50 offen offset:1024 lds
ds_read_b64_tr_b16 a[96:97], v37 offset:32768
ds_read_b64_tr_b16 a[98:99], v37 offset:33792
v_mfma_f32_16x16x32_bf16 v[144:147], a[16:19], a[0:3], v[144:147]
ds_read_b64_tr_b16 a[100:101], v69 offset:32768
ds_read_b64_tr_b16 a[102:103], v69 offset:33792
v_mfma_f32_16x16x32_bf16 v[148:151], a[16:19], a[4:7], v[148:151]
ds_read_b64_tr_b16 a[104:105], v38 offset:32768
v_mfma_f32_16x16x32_bf16 v[152:155], a[20:23], a[0:3], v[152:155]
ds_read_b64_tr_b16 a[106:107], v38 offset:33792
ds_read_b64_tr_b16 a[108:109], v70 offset:32768
v_mfma_f32_16x16x32_bf16 v[156:159], a[20:23], a[4:7], v[156:159]
buffer_load_dwordx4 v8, s[12:15], s50 offen offset:2048 lds
ds_read_b64_tr_b16 a[110:111], v70 offset:33792
ds_read_b64_tr_b16 a[112:113], v39 offset:32768
v_mfma_f32_16x16x32_bf16 v[160:163], a[24:27], a[0:3], v[160:163]
ds_read_b64_tr_b16 a[114:115], v39 offset:33792
ds_read_b64_tr_b16 a[116:117], v71 offset:32768
v_mfma_f32_16x16x32_bf16 v[164:167], a[24:27], a[4:7], v[164:167]
ds_read_b64_tr_b16 a[118:119], v71 offset:33792
ds_read_b128 a[120:123], v34 offset:32768
v_mfma_f32_16x16x32_bf16 v[168:171], a[28:31], a[0:3], v[168:171]
buffer_load_dwordx4 v9, s[12:15], s50 offen offset:3072 lds
ds_read_b128 a[124:127], v34 offset:34816
ds_read_b64_tr_b16 a[128:129], v36 offset:40960
v_mfma_f32_16x16x32_bf16 v[172:175], a[28:31], a[4:7], v[172:175]
ds_read_b64_tr_b16 a[130:131], v36 offset:41984
v_mfma_f32_16x16x32_bf16 v[176:179], a[32:35], a[0:3], v[176:179]
ds_read_b64_tr_b16 a[132:133], v68 offset:40960
ds_read_b64_tr_b16 a[134:135], v68 offset:41984
v_mfma_f32_16x16x32_bf16 v[180:183], a[32:35], a[4:7], v[180:183]
ds_read_b64_tr_b16 a[136:137], v37 offset:40960
ds_read_b64_tr_b16 a[138:139], v37 offset:41984
v_mfma_f32_16x16x32_bf16 v[184:187], a[36:39], a[0:3], v[184:187]
s_add_u32 m0, s47, 0x8000
s_lshl_b32 s49, s49, 7
s_add_u32 s46, s46, 1
s_and_b32 s46, s46, 3
buffer_load_dwordx4 v2, s[8:11], s49 offen offset:0 lds
ds_read_b64_tr_b16 a[140:141], v69 offset:40960
ds_read_b64_tr_b16 a[142:143], v69 offset:41984
v_mfma_f32_16x16x32_bf16 v[188:191], a[36:39], a[4:7], v[188:191]
ds_read_b64_tr_b16 a[144:145], v38 offset:40960
ds_read_b64_tr_b16 a[146:147], v38 offset:41984
v_mfma_f32_16x16x32_bf16 v[128:131], a[48:51], a[40:43], v[128:131]
ds_read_b64_tr_b16 a[148:149], v70 offset:40960
ds_read_b64_tr_b16 a[150:151], v70 offset:41984
v_mfma_f32_16x16x32_bf16 v[132:135], a[48:51], a[44:47], v[132:135]
buffer_load_dwordx4 v3, s[8:11], s49 offen offset:1024 lds
ds_read_b64_tr_b16 a[152:153], v39 offset:40960
v_mfma_f32_16x16x32_bf16 v[136:139], a[52:55], a[40:43], v[136:139]
ds_read_b64_tr_b16 a[154:155], v39 offset:41984
ds_read_b64_tr_b16 a[156:157], v71 offset:40960
v_mfma_f32_16x16x32_bf16 v[140:143], a[52:55], a[44:47], v[140:143]
ds_read_b64_tr_b16 a[158:159], v71 offset:41984
v_xor_b32 v29, 0, v24
ds_read_b128 a[160:163], v29 offset:0
v_mfma_f32_16x16x32_bf16 v[144:147], a[56:59], a[40:43], v[144:147]
v_xor_b32 v29, 32, v24
ds_read_b128 a[164:167], v29 offset:0
v_xor_b32 v29, 64, v24
ds_read_b128 a[168:171], v29 offset:0
v_mfma_f32_16x16x32_bf16 v[148:151], a[56:59], a[44:47], v[148:151]
buffer_load_dwordx4 v4, s[8:11], s49 offen offset:2048 lds
v_xor_b32 v29, 96, v24
ds_read_b128 a[172:175], v29 offset:0
v_xor_b32 v29, 128, v24
ds_read_b128 a[176:179], v29 offset:0
v_mfma_f32_16x16x32_bf16 v[152:155], a[60:63], a[40:43], v[152:155]
v_xor_b32 v29, 160, v24
ds_read_b128 a[180:183], v29 offset:0
v_xor_b32 v29, 192, v24
ds_read_b128 a[184:187], v29 offset:0
v_mfma_f32_16x16x32_bf16 v[156:159], a[60:63], a[44:47], v[156:159]
v_xor_b32 v29, 224, v24
ds_read_b128 a[188:191], v29 offset:0
v_mfma_f32_16x16x32_bf16 v[160:163], a[64:67], a[40:43], v[160:163]
buffer_load_dwordx4 v5, s[8:11], s49 offen offset:3072 lds
v_mfma_f32_16x16x32_bf16 v[164:167], a[64:67], a[44:47], v[164:167]
v_mfma_f32_16x16x32_bf16 v[168:171], a[68:71], a[40:43], v[168:171]
v_mfma_f32_16x16x32_bf16 v[172:175], a[68:71], a[44:47], v[172:175]
v_mfma_f32_16x16x32_bf16 v[176:179], a[72:75], a[40:43], v[176:179]
s_cmp_lg_u32 s88, 1
s_cbranch_scc1 L_pf2
buffer_load_dword v22, v25, s[16:19], s84 offen
L_pf2:
v_mfma_f32_16x16x32_bf16 v[180:183], a[72:75], a[44:47], v[180:183]
v_mfma_f32_16x16x32_bf16 v[184:187], a[76:79], a[40:43], v[184:187]
v_mfma_f32_16x16x32_bf16 v[188:191], a[76:79], a[44:47], v[188:191]
s_waitcnt lgkmcnt(0)
s_waitcnt vmcnt(8)
s_barrier
v_mfma_f32_16x16x32_bf16 v[128:131], a[88:91], a[80:83], v[128:131]
s_add_u32 m0, s47, 0x14000
s_or_b32 s49, s46, 8
s_lshl_b32 s50, s49, 19
buffer_load_dwordx4 v6, s[12:15], s50 offen offset:0 lds
ds_read_b128 a[0:3], v14 offset:0
ds_read_b128 a[4:7], v14 offset:2048
v_mfma_f32_16x16x32_bf16 v[132:135], a[88:91], a[84:87], v[132:135]
ds_read_b64_tr_b16 a[8:9], v18 offset:0
v_mfma_f32_16x16x32_bf16 v[136:139], a[92:95], a[80:83], v[136:139]
ds_read_b64_tr_b16 a[10:11], v18 offset:1024
ds_read_b64_tr_b16 a[12:13], v64 offset:0
v_mfma_f32_16x16x32_bf16 v[140:143], a[92:95], a[84:87], v[140:143]
buffer_load_dwordx4 v7, s[12:15], s50 offen offset:1024 lds
ds_read_b64_tr_b16 a[14:15], v64 offset:1024
v_mfma_f32_16x16x32_bf16 v[144:147], a[96:99], a[80:83], v[144:147]
ds_read_b64_tr_b16 a[16:17], v19 offset:0
ds_read_b64_tr_b16 a[18:19], v19 offset:1024
v_mfma_f32_16x16x32_bf16 v[148:151], a[96:99], a[84:87], v[148:151]
ds_read_b64_tr_b16 a[20:21], v65 offset:0
v_mfma_f32_16x16x32_bf16 v[152:155], a[100:103], a[80:83], v[152:155]
ds_read_b64_tr_b16 a[22:23], v65 offset:1024
ds_read_b64_tr_b16 a[24:25], v20 offset:0
v_mfma_f32_16x16x32_bf16 v[156:159], a[100:103], a[84:87], v[156:159]
buffer_load_dwordx4 v8, s[12:15], s50 offen offset:2048 lds
ds_read_b64_tr_b16 a[26:27], v20 offset:1024
v_mfma_f32_16x16x32_bf16 v[160:163], a[104:107], a[80:83], v[160:163]
ds_read_b64_tr_b16 a[28:29], v66 offset:0
ds_read_b64_tr_b16 a[30:31], v66 offset:1024
v_mfma_f32_16x16x32_bf16 v[164:167], a[104:107], a[84:87], v[164:167]
ds_read_b64_tr_b16 a[32:33], v21 offset:0
v_mfma_f32_16x16x32_bf16 v[168:171], a[108:111], a[80:83], v[168:171]
buffer_load_dwordx4 v9, s[12:15], s50 offen offset:3072 lds
ds_read_b64_tr_b16 a[34:35], v21 offset:1024
ds_read_b64_tr_b16 a[36:37], v67 offset:0
v_mfma_f32_16x16x32_bf16 v[172:175], a[108:111], a[84:87], v[172:175]
ds_read_b64_tr_b16 a[38:39], v67 offset:1024
v_mfma_f32_16x16x32_bf16 v[176:179], a[112:115], a[80:83], v[176:179]
ds_read_b128 a[40:43], v16 offset:0
ds_read_b128 a[44:47], v16 offset:2048
v_mfma_f32_16x16x32_bf16 v[180:183], a[112:115], a[84:87], v[180:183]
ds_read_b64_tr_b16 a[48:49], v18 offset:8192
v_mfma_f32_16x16x32_bf16 v[184:187], a[116:119], a[80:83], v[184:187]
s_add_u32 m0, s47, 0x10000
s_lshl_b32 s49, s49, 7
s_add_u32 s46, s46, 1
s_and_b32 s46, s46, 3
buffer_load_dwordx4 v2, s[8:11], s49 offen offset:0 lds
ds_read_b64_tr_b16 a[50:51], v18 offset:9216
ds_read_b64_tr_b16 a[52:53], v64 offset:8192
v_mfma_f32_16x16x32_bf16 v[188:191], a[116:119], a[84:87], v[188:191]
ds_read_b64_tr_b16 a[54:55], v64 offset:9216
v_mfma_f32_16x16x32_bf16 v[128:131], a[128:131], a[120:123], v[128:131]
ds_read_b64_tr_b16 a[56:57], v19 offset:8192
ds_read_b64_tr_b16 a[58:59], v19 offset:9216
v_mfma_f32_16x16x32_bf16 v[132:135], a[128:131], a[124:127], v[132:135]
buffer_load_dwordx4 v3, s[8:11], s49 offen offset:1024 lds
ds_read_b64_tr_b16 a[60:61], v65 offset:8192
v_mfma_f32_16x16x32_bf16 v[136:139], a[132:135], a[120:123], v[136:139]
ds_read_b64_tr_b16 a[62:63], v65 offset:9216
ds_read_b64_tr_b16 a[64:65], v20 offset:8192
v_mfma_f32_16x16x32_bf16 v[140:143], a[132:135], a[124:127], v[140:143]
ds_read_b64_tr_b16 a[66:67], v20 offset:9216
v_mfma_f32_16x16x32_bf16 v[144:147], a[136:139], a[120:123], v[144:147]
ds_read_b64_tr_b16 a[68:69], v66 offset:8192
ds_read_b64_tr_b16 a[70:71], v66 offset:9216
v_mfma_f32_16x16x32_bf16 v[148:151], a[136:139], a[124:127], v[148:151]
buffer_load_dwordx4 v4, s[8:11], s49 offen offset:2048 lds
ds_read_b64_tr_b16 a[72:73], v21 offset:8192
v_mfma_f32_16x16x32_bf16 v[152:155], a[140:143], a[120:123], v[152:155]
ds_read_b64_tr_b16 a[74:75], v21 offset:9216
ds_read_b64_tr_b16 a[76:77], v67 offset:8192
v_mfma_f32_16x16x32_bf16 v[156:159], a[140:143], a[124:127], v[156:159]
ds_read_b64_tr_b16 a[78:79], v67 offset:9216
v_mfma_f32_16x16x32_bf16 v[160:163], a[144:147], a[120:123], v[160:163]
buffer_load_dwordx4 v5, s[8:11], s49 offen offset:3072 lds
v_mfma_f32_16x16x32_bf16 v[164:167], a[144:147], a[124:127], v[164:167]
v_mfma_f32_16x16x32_bf16 v[168:171], a[148:151], a[120:123], v[168:171]
v_mfma_f32_16x16x32_bf16 v[172:175], a[148:151], a[124:127], v[172:175]
v_mfma_f32_16x16x32_bf16 v[176:179], a[152:155], a[120:123], v[176:179]
s_cmp_lg_u32 s88, 2
s_cbranch_scc1 L_pf3
buffer_load_dword v22, v25, s[16:19], s84 offen
L_pf3:
v_mfma_f32_16x16x32_bf16 v[180:183], a[152:155], a[124:127], v[180:183]
v_mfma_f32_16x16x32_bf16 v[184:187], a[156:159], a[120:123], v[184:187]
v_mfma_f32_16x16x32_bf16 v[188:191], a[156:159], a[124:127], v[188:191]
s_waitcnt lgkmcnt(0)
s_waitcnt vmcnt(8)
s_barrier
v_mfma_f32_16x16x32_bf16 v[128:131], a[8:11], a[0:3], v[128:131]
s_add_u32 m0, s47, 0x1c000
s_or_b32 s49, s46, 8
s_lshl_b32 s50, s49, 19
buffer_load_dwordx4 v6, s[12:15], s50 offen offset:0 lds
ds_read_b128 a[80:83], v14 offset:32768
ds_read_b128 a[84:87], v14 offset:34816
v_mfma_f32_16x16x32_bf16 v[132:135], a[8:11], a[4:7], v[132:135]
ds_read_b64_tr_b16 a[88:89], v18 offset:32768
v_mfma_f32_16x16x32_bf16 v[136:139], a[12:15], a[0:3], v[136:139]
ds_read_b64_tr_b16 a[90:91], v18 offset:33792
ds_read_b64_tr_b16 a[92:93], v64 offset:32768
v_mfma_f32_16x16x32_bf16 v[140:143], a[12:15], a[4:7], v[140:143]
buffer_load_dwordx4 v7, s[12:15], s50 offen offset:1024 lds
ds_read_b64_tr_b16 a[94:95], v64 offset:33792
v_mfma_f32_16x16x32_bf16 v[144:147], a[16:19], a[0:3], v[144:147]
ds_read_b64_tr_b16 a[96:97], v19 offset:32768
ds_read_b64_tr_b16 a[98:99], v19 offset:33792
v_mfma_f32_16x16x32_bf16 v[148:151], a[16:19], a[4:7], v[148:151]
ds_read_b64_tr_b16 a[100:101], v65 offset:32768
v_mfma_f32_16x16x32_bf16 v[152:155], a[20:23], a[0:3], v[152:155]
ds_read_b64_tr_b16 a[102:103], v65 offset:33792
ds_read_b64_tr_b16 a[104:105], v20 offset:32768
v_mfma_f32_16x16x32_bf16 v[156:159], a[20:23], a[4:7], v[156:159]
buffer_load_dwordx4 v8, s[12:15], s50 offen offset:2048 lds
ds_read_b64_tr_b16 a[106:107], v20 offset:33792
v_mfma_f32_16x16x32_bf16 v[160:163], a[24:27], a[0:3], v[160:163]
ds_read_b64_tr_b16 a[108:109], v66 offset:32768
ds_read_b64_tr_b16 a[110:111], v66 offset:33792
v_mfma_f32_16x16x32_bf16 v[164:167], a[24:27], a[4:7], v[164:167]
ds_read_b64_tr_b16 a[112:113], v21 offset:32768
v_mfma_f32_16x16x32_bf16 v[168:171], a[28:31], a[0:3], v[168:171]
buffer_load_dwordx4 v9, s[12:15], s50 offen offset:3072 lds
ds_read_b64_tr_b16 a[114:115], v21 offset:33792
ds_read_b64_tr_b16 a[116:117], v67 offset:32768
v_mfma_f32_16x16x32_bf16 v[172:175], a[28:31], a[4:7], v[172:175]
ds_read_b64_tr_b16 a[118:119], v67 offset:33792
v_mfma_f32_16x16x32_bf16 v[176:179], a[32:35], a[0:3], v[176:179]
ds_read_b128 a[120:123], v16 offset:32768
ds_read_b128 a[124:127], v16 offset:34816
v_mfma_f32_16x16x32_bf16 v[180:183], a[32:35], a[4:7], v[180:183]
ds_read_b64_tr_b16 a[128:129], v18 offset:40960
v_mfma_f32_16x16x32_bf16 v[184:187], a[36:39], a[0:3], v[184:187]
s_add_u32 m0, s47, 0x18000
s_lshl_b32 s49, s49, 7
s_add_u32 s46, s46, 1
s_and_b32 s46, s46, 3
buffer_load_dwordx4 v2, s[8:11], s49 offen offset:0 lds
ds_read_b64_tr_b16 a[130:131], v18 offset:41984
ds_read_b64_tr_b16 a[132:133], v64 offset:40960
v_mfma_f32_16x16x32_bf16 v[188:191], a[36:39], a[4:7], v[188:191]
ds_read_b64_tr_b16 a[134:135], v64 offset:41984
v_mfma_f32_16x16x32_bf16 v[128:131], a[48:51], a[40:43], v[128:131]
ds_read_b64_tr_b16 a[136:137], v19 offset:40960
ds_read_b64_tr_b16 a[138:139], v19 offset:41984
v_mfma_f32_16x16x32_bf16 v[132:135], a[48:51], a[44:47], v[132:135]
buffer_load_dwordx4 v3, s[8:11], s49 offen offset:1024 lds
ds_read_b64_tr_b16 a[140:141], v65 offset:40960
v_mfma_f32_16x16x32_bf16 v[136:139], a[52:55], a[40:43], v[136:139]
ds_read_b64_tr_b16 a[142:143], v65 offset:41984
ds_read_b64_tr_b16 a[144:145], v20 offset:40960
v_mfma_f32_16x16x32_bf16 v[140:143], a[52:55], a[44:47], v[140:143]
ds_read_b64_tr_b16 a[146:147], v20 offset:41984
v_mfma_f32_16x16x32_bf16 v[144:147], a[56:59], a[40:43], v[144:147]
ds_read_b64_tr_b16 a[148:149], v66 offset:40960
ds_read_b64_tr_b16 a[150:151], v66 offset:41984
v_mfma_f32_16x16x32_bf16 v[148:151], a[56:59], a[44:47], v[148:151]
buffer_load_dwordx4 v4, s[8:11], s49 offen offset:2048 lds
ds_read_b64_tr_b16 a[152:153], v21 offset:40960
v_mfma_f32_16x16x32_bf16 v[152:155], a[60:63], a[40:43], v[152:155]
ds_read_b64_tr_b16 a[154:155], v21 offset:41984
ds_read_b64_tr_b16 a[156:157], v67 offset:40960
v_mfma_f32_16x16x32_bf16 v[156:159], a[60:63], a[44:47], v[156:159]
ds_read_b64_tr_b16 a[158:159], v67 offset:41984
v_mfma_f32_16x16x32_bf16 v[160:163], a[64:67], a[40:43], v[160:163]
buffer_load_dwordx4 v5, s[8:11], s49 offen offset:3072 lds
v_mfma_f32_16x16x32_bf16 v[164:167], a[64:67], a[44:47], v[164:167]
v_mfma_f32_16x16x32_bf16 v[168:171], a[68:71], a[40:43], v[168:171]
v_mfma_f32_16x16x32_bf16 v[172:175], a[68:71], a[44:47], v[172:175]
v_mfma_f32_16x16x32_bf16 v[176:179], a[72:75], a[40:43], v[176:179]
s_cmp_lg_u32 s88, 3
s_cbranch_scc1 L_pf4
buffer_load_dword v22, v25, s[16:19], s84 offen
L_pf4:
v_mfma_f32_16x16x32_bf16 v[180:183], a[72:75], a[44:47], v[180:183]
v_mfma_f32_16x16x32_bf16 v[184:187], a[76:79], a[40:43], v[184:187]
v_mfma_f32_16x16x32_bf16 v[188:191], a[76:79], a[44:47], v[188:191]
s_waitcnt lgkmcnt(0)
s_waitcnt vmcnt(8)
s_barrier
v_mfma_f32_16x16x32_bf16 v[128:131], a[88:91], a[80:83], v[128:131]
s_add_u32 m0, s47, 0x4000
s_or_b32 s49, s46, 12
s_lshl_b32 s50, s49, 19
buffer_load_dwordx4 v6, s[12:15], s50 offen offset:0 lds
ds_read_b128 a[0:3], v32 offset:0
ds_read_b128 a[4:7], v32 offset:2048
v_mfma_f32_16x16x32_bf16 v[132:135], a[88:91], a[84:87], v[132:135]
ds_read_b64_tr_b16 a[8:9], v36 offset:0
v_mfma_f32_16x16x32_bf16 v[136:139], a[92:95], a[80:83], v[136:139]
ds_read_b64_tr_b16 a[10:11], v36 offset:1024
ds_read_b64_tr_b16 a[12:13], v68 offset:0
v_mfma_f32_16x16x32_bf16 v[140:143], a[92:95], a[84:87], v[140:143]
buffer_load_dwordx4 v7, s[12:15], s50 offen offset:1024 lds
ds_read_b64_tr_b16 a[14:15], v68 offset:1024
v_mfma_f32_16x16x32_bf16 v[144:147], a[96:99], a[80:83], v[144:147]
ds_read_b64_tr_b16 a[16:17], v37 offset:0
ds_read_b64_tr_b16 a[18:19], v37 offset:1024
v_mfma_f32_16x16x32_bf16 v[148:151], a[96:99], a[84:87], v[148:151]
ds_read_b64_tr_b16 a[20:21], v69 offset:0
v_mfma_f32_16x16x32_bf16 v[152:155], a[100:103], a[80:83], v[152:155]
ds_read_b64_tr_b16 a[22:23], v69 offset:1024
ds_read_b64_tr_b16 a[24:25], v38 offset:0
v_mfma_f32_16x16x32_bf16 v[156:159], a[100:103], a[84:87], v[156:159]
buffer_load_dwordx4 v8, s[12:15], s50 offen offset:2048 lds
ds_read_b64_tr_b16 a[26:27], v38 offset:1024
v_mfma_f32_16x16x32_bf16 v[160:163], a[104:107], a[80:83], v[160:163]
ds_read_b64_tr_b16 a[28:29], v70 offset:0
ds_read_b64_tr_b16 a[30:31], v70 offset:1024
v_mfma_f32_16x16x32_bf16 v[164:167], a[104:107], a[84:87], v[164:167]
ds_read_b64_tr_b16 a[32:33], v39 offset:0
v_mfma_f32_16x16x32_bf16 v[168:171], a[108:111], a[80:83], v[168:171]
buffer_load_dwordx4 v9, s[12:15], s50 offen offset:3072 lds
ds_read_b64_tr_b16 a[34:35], v39 offset:1024
ds_read_b64_tr_b16 a[36:37], v71 offset:0
v_mfma_f32_16x16x32_bf16 v[172:175], a[108:111], a[84:87], v[172:175]
ds_read_b64_tr_b16 a[38:39], v71 offset:1024
v_mfma_f32_16x16x32_bf16 v[176:179], a[112:115], a[80:83], v[176:179]
ds_read_b128 a[40:43], v34 offset:0
ds_read_b128 a[44:47], v34 offset:2048
v_mfma_f32_16x16x32_bf16 v[180:183], a[112:115], a[84:87], v[180:183]
ds_read_b64_tr_b16 a[48:49], v36 offset:8192
v_mfma_f32_16x16x32_bf16 v[184:187], a[116:119], a[80:83], v[184:187]
s_add_u32 m0, s47, 0x0
s_lshl_b32 s49, s49, 7
s_add_u32 s46, s46, 1
s_and_b32 s46, s46, 3
buffer_load_dwordx4 v2, s[8:11], s49 offen offset:0 lds
ds_read_b64_tr_b16 a[50:51], v36 offset:9216
ds_read_b64_tr_b16 a[52:53], v68 offset:8192
v_mfma_f32_16x16x32_bf16 v[188:191], a[116:119], a[84:87], v[188:191]
ds_read_b64_tr_b16 a[54:55], v68 offset:9216
v_mfma_f32_16x16x32_bf16 v[128:131], a[128:131], a[120:123], v[128:131]
ds_read_b64_tr_b16 a[56:57], v37 offset:8192
ds_read_b64_tr_b16 a[58:59], v37 offset:9216
v_mfma_f32_16x16x32_bf16 v[132:135], a[128:131], a[124:127], v[132:135]
buffer_load_dwordx4 v3, s[8:11], s49 offen offset:1024 lds
ds_read_b64_tr_b16 a[60:61], v69 offset:8192
v_mfma_f32_16x16x32_bf16 v[136:139], a[132:135], a[120:123], v[136:139]
ds_read_b64_tr_b16 a[62:63], v69 offset:9216
ds_read_b64_tr_b16 a[64:65], v38 offset:8192
v_mfma_f32_16x16x32_bf16 v[140:143], a[132:135], a[124:127], v[140:143]
ds_read_b64_tr_b16 a[66:67], v38 offset:9216
v_mfma_f32_16x16x32_bf16 v[144:147], a[136:139], a[120:123], v[144:147]
ds_read_b64_tr_b16 a[68:69], v70 offset:8192
ds_read_b64_tr_b16 a[70:71], v70 offset:9216
v_mfma_f32_16x16x32_bf16 v[148:151], a[136:139], a[124:127], v[148:151]
buffer_load_dwordx4 v4, s[8:11], s49 offen offset:2048 lds
ds_read_b64_tr_b16 a[72:73], v39 offset:8192
v_mfma_f32_16x16x32_bf16 v[152:155], a[140:143], a[120:123], v[152:155]
ds_read_b64_tr_b16 a[74:75], v39 offset:9216
ds_read_b64_tr_b16 a[76:77], v71 offset:8192
v_mfma_f32_16x16x32_bf16 v[156:159], a[140:143], a[124:127], v[156:159]
ds_read_b64_tr_b16 a[78:79], v71 offset:9216
v_mfma_f32_16x16x32_bf16 v[160:163], a[144:147], a[120:123], v[160:163]
buffer_load_dwordx4 v5, s[8:11], s49 offen offset:3072 lds
v_mfma_f32_16x16x32_bf16 v[164:167], a[144:147], a[124:127], v[164:167]
v_mfma_f32_16x16x32_bf16 v[168:171], a[148:151], a[120:123], v[168:171]
v_mfma_f32_16x16x32_bf16 v[172:175], a[148:151], a[124:127], v[172:175]
v_mfma_f32_16x16x32_bf16 v[176:179], a[152:155], a[120:123], v[176:179]
s_cmp_lg_u32 s88, 4
s_cbranch_scc1 L_pf5
buffer_load_dword v22, v25, s[16:19], s84 offen
L_pf5:
v_mfma_f32_16x16x32_bf16 v[180:183], a[152:155], a[124:127], v[180:183]
v_mfma_f32_16x16x32_bf16 v[184:187], a[156:159], a[120:123], v[184:187]
v_mfma_f32_16x16x32_bf16 v[188:191], a[156:159], a[124:127], v[188:191]
s_waitcnt lgkmcnt(0)
s_waitcnt vmcnt(8)
s_barrier
v_mfma_f32_16x16x32_bf16 v[128:131], a[8:11], a[0:3], v[128:131]
s_add_u32 m0, s47, 0xc000
s_or_b32 s49, s46, 12
s_lshl_b32 s50, s49, 19
buffer_load_dwordx4 v6, s[12:15], s50 offen offset:0 lds
ds_read_b128 a[80:83], v32 offset:32768
ds_read_b128 a[84:87], v32 offset:34816
v_mfma_f32_16x16x32_bf16 v[132:135], a[8:11], a[4:7], v[132:135]
ds_read_b64_tr_b16 a[88:89], v36 offset:32768
v_mfma_f32_16x16x32_bf16 v[136:139], a[12:15], a[0:3], v[136:139]
ds_read_b64_tr_b16 a[90:91], v36 offset:33792
ds_read_b64_tr_b16 a[92:93], v68 offset:32768
v_mfma_f32_16x16x32_bf16 v[140:143], a[12:15], a[4:7], v[140:143]
buffer_load_dwordx4 v7, s[12:15], s50 offen offset:1024 lds
ds_read_b64_tr_b16 a[94:95], v68 offset:33792
v_mfma_f32_16x16x32_bf16 v[144:147], a[16:19], a[0:3], v[144:147]
ds_read_b64_tr_b16 a[96:97], v37 offset:32768
ds_read_b64_tr_b16 a[98:99], v37 offset:33792
v_mfma_f32_16x16x32_bf16 v[148:151], a[16:19], a[4:7], v[148:151]
ds_read_b64_tr_b16 a[100:101], v69 offset:32768
v_mfma_f32_16x16x32_bf16 v[152:155], a[20:23], a[0:3], v[152:155]
ds_read_b64_tr_b16 a[102:103], v69 offset:33792
ds_read_b64_tr_b16 a[104:105], v38 offset:32768
v_mfma_f32_16x16x32_bf16 v[156:159], a[20:23], a[4:7], v[156:159]
buffer_load_dwordx4 v8, s[12:15], s50 offen offset:2048 lds
ds_read_b64_tr_b16 a[106:107], v38 offset:33792
v_mfma_f32_16x16x32_bf16 v[160:163], a[24:27], a[0:3], v[160:163]
ds_read_b64_tr_b16 a[108:109], v70 offset:32768
ds_read_b64_tr_b16 a[110:111], v70 offset:33792
v_mfma_f32_16x16x32_bf16 v[164:167], a[24:27], a[4:7], v[164:167]
ds_read_b64_tr_b16 a[112:113], v39 offset:32768
v_mfma_f32_16x16x32_bf16 v[168:171], a[28:31], a[0:3], v[168:171]
buffer_load_dwordx4 v9, s[12:15], s50 offen offset:3072 lds
ds_read_b64_tr_b16 a[114:115], v39 offset:33792
ds_read_b64_tr_b16 a[116:117], v71 offset:32768
v_mfma_f32_16x16x32_bf16 v[172:175], a[28:31], a[4:7], v[172:175]
ds_read_b64_tr_b16 a[118:119], v71 offset:33792
v_mfma_f32_16x16x32_bf16 v[176:179], a[32:35], a[0:3], v[176:179]
ds_read_b128 a[120:123], v34 offset:32768
ds_read_b128 a[124:127], v34 offset:34816
v_mfma_f32_16x16x32_bf16 v[180:183], a[32:35], a[4:7], v[180:183]
ds_read_b64_tr_b16 a[128:129], v36 offset:40960
v_mfma_f32_16x16x32_bf16 v[184:187], a[36:39], a[0:3], v[184:187]
s_add_u32 m0, s47, 0x8000
s_lshl_b32 s49, s49, 7
s_add_u32 s46, s46, 1
s_and_b32 s46, s46, 3
buffer_load_dwordx4 v2, s[8:11], s49 offen offset:0 lds
ds_read_b64_tr_b16 a[130:131], v36 offset:41984
ds_read_b64_tr_b16 a[132:133], v68 offset:40960
v_mfma_f32_16x16x32_bf16 v[188:191], a[36:39], a[4:7], v[188:191]
ds_read_b64_tr_b16 a[134:135], v68 offset:41984
v_mfma_f32_16x16x32_bf16 v[128:131], a[48:51], a[40:43], v[128:131]
ds_read_b64_tr_b16 a[136:137], v37 offset:40960
ds_read_b64_tr_b16 a[138:139], v37 offset:41984
v_mfma_f32_16x16x32_bf16 v[132:135], a[48:51], a[44:47], v[132:135]
buffer_load_dwordx4 v3, s[8:11], s49 offen offset:1024 lds
ds_read_b64_tr_b16 a[140:141], v69 offset:40960
v_mfma_f32_16x16x32_bf16 v[136:139], a[52:55], a[40:43], v[136:139]
ds_read_b64_tr_b16 a[142:143], v69 offset:41984
ds_read_b64_tr_b16 a[144:145], v38 offset:40960
v_mfma_f32_16x16x32_bf16 v[140:143], a[52:55], a[44:47], v[140:143]
ds_read_b64_tr_b16 a[146:147], v38 offset:41984
v_mfma_f32_16x16x32_bf16 v[144:147], a[56:59], a[40:43], v[144:147]
ds_read_b64_tr_b16 a[148:149], v70 offset:40960
ds_read_b64_tr_b16 a[150:151], v70 offset:41984
v_mfma_f32_16x16x32_bf16 v[148:151], a[56:59], a[44:47], v[148:151]
buffer_load_dwordx4 v4, s[8:11], s49 offen offset:2048 lds
ds_read_b64_tr_b16 a[152:153], v39 offset:40960
v_mfma_f32_16x16x32_bf16 v[152:155], a[60:63], a[40:43], v[152:155]
ds_read_b64_tr_b16 a[154:155], v39 offset:41984
ds_read_b64_tr_b16 a[156:157], v71 offset:40960
v_mfma_f32_16x16x32_bf16 v[156:159], a[60:63], a[44:47], v[156:159]
ds_read_b64_tr_b16 a[158:159], v71 offset:41984
v_mfma_f32_16x16x32_bf16 v[160:163], a[64:67], a[40:43], v[160:163]
buffer_load_dwordx4 v5, s[8:11], s49 offen offset:3072 lds
v_mfma_f32_16x16x32_bf16 v[164:167], a[64:67], a[44:47], v[164:167]
v_mfma_f32_16x16x32_bf16 v[168:171], a[68:71], a[40:43], v[168:171]
v_mfma_f32_16x16x32_bf16 v[172:175], a[68:71], a[44:47], v[172:175]
v_mfma_f32_16x16x32_bf16 v[176:179], a[72:75], a[40:43], v[176:179]
s_cmp_lg_u32 s88, 5
s_cbranch_scc1 L_pf6
buffer_load_dword v22, v25, s[16:19], s84 offen
L_pf6:
v_mfma_f32_16x16x32_bf16 v[180:183], a[72:75], a[44:47], v[180:183]
v_mfma_f32_16x16x32_bf16 v[184:187], a[76:79], a[40:43], v[184:187]
v_mfma_f32_16x16x32_bf16 v[188:191], a[76:79], a[44:47], v[188:191]
s_waitcnt lgkmcnt(0)
s_waitcnt vmcnt(8)
s_barrier
v_mfma_f32_16x16x32_bf16 v[128:131], a[88:91], a[80:83], v[128:131]
s_add_u32 m0, s47, 0x14000
s_or_b32 s49, s46, 12
s_lshl_b32 s50, s49, 19
buffer_load_dwordx4 v6, s[12:15], s50 offen offset:0 lds
ds_read_b128 a[0:3], v14 offset:0
ds_read_b128 a[4:7], v14 offset:2048
v_mfma_f32_16x16x32_bf16 v[132:135], a[88:91], a[84:87], v[132:135]
ds_read_b64_tr_b16 a[8:9], v18 offset:0
v_mfma_f32_16x16x32_bf16 v[136:139], a[92:95], a[80:83], v[136:139]
ds_read_b64_tr_b16 a[10:11], v18 offset:1024
ds_read_b64_tr_b16 a[12:13], v64 offset:0
v_mfma_f32_16x16x32_bf16 v[140:143], a[92:95], a[84:87], v[140:143]
buffer_load_dwordx4 v7, s[12:15], s50 offen offset:1024 lds
ds_read_b64_tr_b16 a[14:15], v64 offset:1024
v_mfma_f32_16x16x32_bf16 v[144:147], a[96:99], a[80:83], v[144:147]
ds_read_b64_tr_b16 a[16:17], v19 offset:0
ds_read_b64_tr_b16 a[18:19], v19 offset:1024
v_mfma_f32_16x16x32_bf16 v[148:151], a[96:99], a[84:87], v[148:151]
ds_read_b64_tr_b16 a[20:21], v65 offset:0
v_mfma_f32_16x16x32_bf16 v[152:155], a[100:103], a[80:83], v[152:155]
ds_read_b64_tr_b16 a[22:23], v65 offset:1024
ds_read_b64_tr_b16 a[24:25], v20 offset:0
v_mfma_f32_16x16x32_bf16 v[156:159], a[100:103], a[84:87], v[156:159]
buffer_load_dwordx4 v8, s[12:15], s50 offen offset:2048 lds
ds_read_b64_tr_b16 a[26:27], v20 offset:1024
v_mfma_f32_16x16x32_bf16 v[160:163], a[104:107], a[80:83], v[160:163]
ds_read_b64_tr_b16 a[28:29], v66 offset:0
ds_read_b64_tr_b16 a[30:31], v66 offset:1024
v_mfma_f32_16x16x32_bf16 v[164:167], a[104:107], a[84:87], v[164:167]
ds_read_b64_tr_b16 a[32:33], v21 offset:0
v_mfma_f32_16x16x32_bf16 v[168:171], a[108:111], a[80:83], v[168:171]
buffer_load_dwordx4 v9, s[12:15], s50 offen offset:3072 lds
ds_read_b64_tr_b16 a[34:35], v21 offset:1024
ds_read_b64_tr_b16 a[36:37], v67 offset:0
v_mfma_f32_16x16x32_bf16 v[172:175], a[108:111], a[84:87], v[172:175]
ds_read_b64_tr_b16 a[38:39], v67 offset:1024
v_mfma_f32_16x16x32_bf16 v[176:179], a[112:115], a[80:83], v[176:179]
ds_read_b128 a[40:43], v16 offset:0
ds_read_b128 a[44:47], v16 offset:2048
v_mfma_f32_16x16x32_bf16 v[180:183], a[112:115], a[84:87], v[180:183]
ds_read_b64_tr_b16 a[48:49], v18 offset:8192
v_mfma_f32_16x16x32_bf16 v[184:187], a[116:119], a[80:83], v[184:187]
s_add_u32 m0, s47, 0x10000
s_lshl_b32 s49, s49, 7
s_add_u32 s46, s46, 1
s_and_b32 s46, s46, 3
buffer_load_dwordx4 v2, s[8:11], s49 offen offset:0 lds
ds_read_b64_tr_b16 a[50:51], v18 offset:9216
ds_read_b64_tr_b16 a[52:53], v64 offset:8192
v_mfma_f32_16x16x32_bf16 v[188:191], a[116:119], a[84:87], v[188:191]
ds_read_b64_tr_b16 a[54:55], v64 offset:9216
v_mfma_f32_16x16x32_bf16 v[128:131], a[128:131], a[120:123], v[128:131]
ds_read_b64_tr_b16 a[56:57], v19 offset:8192
ds_read_b64_tr_b16 a[58:59], v19 offset:9216
v_mfma_f32_16x16x32_bf16 v[132:135], a[128:131], a[124:127], v[132:135]
buffer_load_dwordx4 v3, s[8:11], s49 offen offset:1024 lds
ds_read_b64_tr_b16 a[60:61], v65 offset:8192
v_mfma_f32_16x16x32_bf16 v[136:139], a[132:135], a[120:123], v[136:139]
ds_read_b64_tr_b16 a[62:63], v65 offset:9216
ds_read_b64_tr_b16 a[64:65], v20 offset:8192
v_mfma_f32_16x16x32_bf16 v[140:143], a[132:135], a[124:127], v[140:143]
ds_read_b64_tr_b16 a[66:67], v20 offset:9216
v_mfma_f32_16x16x32_bf16 v[144:147], a[136:139], a[120:123], v[144:147]
ds_read_b64_tr_b16 a[68:69], v66 offset:8192
ds_read_b64_tr_b16 a[70:71], v66 offset:9216
v_mfma_f32_16x16x32_bf16 v[148:151], a[136:139], a[124:127], v[148:151]
buffer_load_dwordx4 v4, s[8:11], s49 offen offset:2048 lds
ds_read_b64_tr_b16 a[72:73], v21 offset:8192
v_mfma_f32_16x16x32_bf16 v[152:155], a[140:143], a[120:123], v[152:155]
ds_read_b64_tr_b16 a[74:75], v21 offset:9216
ds_read_b64_tr_b16 a[76:77], v67 offset:8192
v_mfma_f32_16x16x32_bf16 v[156:159], a[140:143], a[124:127], v[156:159]
ds_read_b64_tr_b16 a[78:79], v67 offset:9216
v_mfma_f32_16x16x32_bf16 v[160:163], a[144:147], a[120:123], v[160:163]
buffer_load_dwordx4 v5, s[8:11], s49 offen offset:3072 lds
v_mfma_f32_16x16x32_bf16 v[164:167], a[144:147], a[124:127], v[164:167]
v_mfma_f32_16x16x32_bf16 v[168:171], a[148:151], a[120:123], v[168:171]
v_mfma_f32_16x16x32_bf16 v[172:175], a[148:151], a[124:127], v[172:175]
v_mfma_f32_16x16x32_bf16 v[176:179], a[152:155], a[120:123], v[176:179]
s_cmp_lg_u32 s88, 6
s_cbranch_scc1 L_pf7
buffer_load_dword v22, v25, s[16:19], s84 offen
L_pf7:
v_mfma_f32_16x16x32_bf16 v[180:183], a[152:155], a[124:127], v[180:183]
v_mfma_f32_16x16x32_bf16 v[184:187], a[156:159], a[120:123], v[184:187]
v_mfma_f32_16x16x32_bf16 v[188:191], a[156:159], a[124:127], v[188:191]
s_waitcnt lgkmcnt(0)
s_waitcnt vmcnt(8)
s_barrier
v_mfma_f32_16x16x32_bf16 v[128:131], a[8:11], a[0:3], v[128:131]
s_add_u32 m0, s47, 0x1c000
s_or_b32 s49, s46, 12
s_lshl_b32 s50, s49, 19
buffer_load_dwordx4 v6, s[12:15], s50 offen offset:0 lds
ds_read_b128 a[80:83], v14 offset:32768
ds_read_b128 a[84:87], v14 offset:34816
v_mfma_f32_16x16x32_bf16 v[132:135], a[8:11], a[4:7], v[132:135]
ds_read_b64_tr_b16 a[88:89], v18 offset:32768
v_mfma_f32_16x16x32_bf16 v[136:139], a[12:15], a[0:3], v[136:139]
ds_read_b64_tr_b16 a[90:91], v18 offset:33792
ds_read_b64_tr_b16 a[92:93], v64 offset:32768
v_mfma_f32_16x16x32_bf16 v[140:143], a[12:15], a[4:7], v[140:143]
buffer_load_dwordx4 v7, s[12:15], s50 offen offset:1024 lds
ds_read_b64_tr_b16 a[94:95], v64 offset:33792
v_mfma_f32_16x16x32_bf16 v[144:147], a[16:19], a[0:3], v[144:147]
ds_read_b64_tr_b16 a[96:97], v19 offset:32768
ds_read_b64_tr_b16 a[98:99], v19 offset:33792
v_mfma_f32_16x16x32_bf16 v[148:151], a[16:19], a[4:7], v[148:151]
ds_read_b64_tr_b16 a[100:101], v65 offset:32768
v_mfma_f32_16x16x32_bf16 v[152:155], a[20:23], a[0:3], v[152:155]
ds_read_b64_tr_b16 a[102:103], v65 offset:33792
ds_read_b64_tr_b16 a[104:105], v20 offset:32768
v_mfma_f32_16x16x32_bf16 v[156:159], a[20:23], a[4:7], v[156:159]
buffer_load_dwordx4 v8, s[12:15], s50 offen offset:2048 lds
ds_read_b64_tr_b16 a[106:107], v20 offset:33792
v_mfma_f32_16x16x32_bf16 v[160:163], a[24:27], a[0:3], v[160:163]
ds_read_b64_tr_b16 a[108:109], v66 offset:32768
ds_read_b64_tr_b16 a[110:111], v66 offset:33792
v_mfma_f32_16x16x32_bf16 v[164:167], a[24:27], a[4:7], v[164:167]
ds_read_b64_tr_b16 a[112:113], v21 offset:32768
v_mfma_f32_16x16x32_bf16 v[168:171], a[28:31], a[0:3], v[168:171]
buffer_load_dwordx4 v9, s[12:15], s50 offen offset:3072 lds
ds_read_b64_tr_b16 a[114:115], v21 offset:33792
ds_read_b64_tr_b16 a[116:117], v67 offset:32768
v_mfma_f32_16x16x32_bf16 v[172:175], a[28:31], a[4:7], v[172:175]
ds_read_b64_tr_b16 a[118:119], v67 offset:33792
v_mfma_f32_16x16x32_bf16 v[176:179], a[32:35], a[0:3], v[176:179]
ds_read_b128 a[120:123], v16 offset:32768
ds_read_b128 a[124:127], v16 offset:34816
v_mfma_f32_16x16x32_bf16 v[180:183], a[32:35], a[4:7], v[180:183]
ds_read_b64_tr_b16 a[128:129], v18 offset:40960
v_mfma_f32_16x16x32_bf16 v[184:187], a[36:39], a[0:3], v[184:187]
s_add_u32 m0, s47, 0x18000
s_lshl_b32 s49, s49, 7
s_add_u32 s46, s46, 1
s_and_b32 s46, s46, 3
buffer_load_dwordx4 v2, s[8:11], s49 offen offset:0 lds
ds_read_b64_tr_b16 a[130:131], v18 offset:41984
ds_read_b64_tr_b16 a[132:133], v64 offset:40960
v_mfma_f32_16x16x32_bf16 v[188:191], a[36:39], a[4:7], v[188:191]
ds_read_b64_tr_b16 a[134:135], v64 offset:41984
v_mfma_f32_16x16x32_bf16 v[128:131], a[48:51], a[40:43], v[128:131]
ds_read_b64_tr_b16 a[136:137], v19 offset:40960
ds_read_b64_tr_b16 a[138:139], v19 offset:41984
v_mfma_f32_16x16x32_bf16 v[132:135], a[48:51], a[44:47], v[132:135]
buffer_load_dwordx4 v3, s[8:11], s49 offen offset:1024 lds
ds_read_b64_tr_b16 a[140:141], v65 offset:40960
v_mfma_f32_16x16x32_bf16 v[136:139], a[52:55], a[40:43], v[136:139]
ds_read_b64_tr_b16 a[142:143], v65 offset:41984
ds_read_b64_tr_b16 a[144:145], v20 offset:40960
v_mfma_f32_16x16x32_bf16 v[140:143], a[52:55], a[44:47], v[140:143]
ds_read_b64_tr_b16 a[146:147], v20 offset:41984
v_mfma_f32_16x16x32_bf16 v[144:147], a[56:59], a[40:43], v[144:147]
ds_read_b64_tr_b16 a[148:149], v66 offset:40960
ds_read_b64_tr_b16 a[150:151], v66 offset:41984
v_mfma_f32_16x16x32_bf16 v[148:151], a[56:59], a[44:47], v[148:151]
buffer_load_dwordx4 v4, s[8:11], s49 offen offset:2048 lds
ds_read_b64_tr_b16 a[152:153], v21 offset:40960
v_mfma_f32_16x16x32_bf16 v[152:155], a[60:63], a[40:43], v[152:155]
ds_read_b64_tr_b16 a[154:155], v21 offset:41984
ds_read_b64_tr_b16 a[156:157], v67 offset:40960
v_mfma_f32_16x16x32_bf16 v[156:159], a[60:63], a[44:47], v[156:159]
ds_read_b64_tr_b16 a[158:159], v67 offset:41984
v_mfma_f32_16x16x32_bf16 v[160:163], a[64:67], a[40:43], v[160:163]
buffer_load_dwordx4 v5, s[8:11], s49 offen offset:3072 lds
v_mfma_f32_16x16x32_bf16 v[164:167], a[64:67], a[44:47], v[164:167]
v_mfma_f32_16x16x32_bf16 v[168:171], a[68:71], a[40:43], v[168:171]
v_mfma_f32_16x16x32_bf16 v[172:175], a[68:71], a[44:47], v[172:175]
v_mfma_f32_16x16x32_bf16 v[176:179], a[72:75], a[40:43], v[176:179]
s_cmp_lg_u32 s88, 7
s_cbranch_scc1 L_pf8
buffer_load_dword v22, v25, s[16:19], s84 offen
L_pf8:
v_mfma_f32_16x16x32_bf16 v[180:183], a[72:75], a[44:47], v[180:183]
v_mfma_f32_16x16x32_bf16 v[184:187], a[76:79], a[40:43], v[184:187]
v_mfma_f32_16x16x32_bf16 v[188:191], a[76:79], a[44:47], v[188:191]
s_waitcnt lgkmcnt(0)
s_waitcnt vmcnt(8)
s_barrier
v_mfma_f32_16x16x32_bf16 v[128:131], a[88:91], a[80:83], v[128:131]
s_add_u32 m0, s48, 0x0
s_add_u32 s51, s53, 0
buffer_load_dwordx4 v10, s[24:27], s51 offen offset:0 lds
ds_read_b128 a[0:3], v32 offset:0
ds_read_b128 a[4:7], v32 offset:2048
v_mfma_f32_16x16x32_bf16 v[132:135], a[88:91], a[84:87], v[132:135]
ds_read_b64_tr_b16 a[8:9], v36 offset:0
v_mfma_f32_16x16x32_bf16 v[136:139], a[92:95], a[80:83], v[136:139]
ds_read_b64_tr_b16 a[10:11], v36 offset:1024
ds_read_b64_tr_b16 a[12:13], v68 offset:0
v_mfma_f32_16x16x32_bf16 v[140:143], a[92:95], a[84:87], v[140:143]
buffer_load_dwordx4 v11, s[24:27], s51 offen offset:1024 lds
ds_read_b64_tr_b16 a[14:15], v68 offset:1024
v_mfma_f32_16x16x32_bf16 v[144:147], a[96:99], a[80:83], v[144:147]
ds_read_b64_tr_b16 a[16:17], v37 offset:0
ds_read_b64_tr_b16 a[18:19], v37 offset:1024
v_mfma_f32_16x16x32_bf16 v[148:151], a[96:99], a[84:87], v[148:151]
ds_read_b64_tr_b16 a[20:21], v69 offset:0
v_mfma_f32_16x16x32_bf16 v[152:155], a[100:103], a[80:83], v[152:155]
buffer_load_dwordx4 v12, s[24:27], s51 offen offset:2048 lds
ds_read_b64_tr_b16 a[22:23], v69 offset:1024
ds_read_b64_tr_b16 a[24:25], v38 offset:0
v_mfma_f32_16x16x32_bf16 v[156:159], a[100:103], a[84:87], v[156:159]
ds_read_b64_tr_b16 a[26:27], v38 offset:1024
v_mfma_f32_16x16x32_bf16 v[160:163], a[104:107], a[80:83], v[160:163]
ds_read_b64_tr_b16 a[28:29], v70 offset:0
ds_read_b64_tr_b16 a[30:31], v70 offset:1024
v_mfma_f32_16x16x32_bf16 v[164:167], a[104:107], a[84:87], v[164:167]
buffer_load_dwordx4 v13, s[24:27], s51 offen offset:3072 lds
ds_read_b64_tr_b16 a[32:33], v39 offset:0
v_mfma_f32_16x16x32_bf16 v[168:171], a[108:111], a[80:83], v[168:171]
ds_read_b64_tr_b16 a[34:35], v39 offset:1024
ds_read_b64_tr_b16 a[36:37], v71 offset:0
v_mfma_f32_16x16x32_bf16 v[172:175], a[108:111], a[84:87], v[172:175]
ds_read_b64_tr_b16 a[38:39], v71 offset:1024
v_mfma_f32_16x16x32_bf16 v[176:179], a[112:115], a[80:83], v[176:179]
s_add_u32 m0, s48, 0x1000
s_add_u32 s51, s53, 4096
buffer_load_dwordx4 v10, s[24:27], s51 offen offset:0 lds
ds_read_b128 a[40:43], v34 offset:0
ds_read_b128 a[44:47], v34 offset:2048
v_mfma_f32_16x16x32_bf16 v[180:183], a[112:115], a[84:87], v[180:183]
ds_read_b64_tr_b16 a[48:49], v36 offset:8192
v_mfma_f32_16x16x32_bf16 v[184:187], a[116:119], a[80:83], v[184:187]
ds_read_b64_tr_b16 a[50:51], v36 offset:9216
ds_read_b64_tr_b16 a[52:53], v68 offset:8192
v_mfma_f32_16x16x32_bf16 v[188:191], a[116:119], a[84:87], v[188:191]
ds_read_b64_tr_b16 a[54:55], v68 offset:9216
v_mfma_f32_16x16x32_bf16 v[128:131], a[128:131], a[120:123], v[128:131]
buffer_load_dwordx4 v11, s[24:27], s51 offen offset:1024 lds
ds_read_b64_tr_b16 a[56:57], v37 offset:8192
ds_read_b64_tr_b16 a[58:59], v37 offset:9216
v_mfma_f32_16x16x32_bf16 v[132:135], a[128:131], a[124:127], v[132:135]
ds_read_b64_tr_b16 a[60:61], v69 offset:8192
v_mfma_f32_16x16x32_bf16 v[136:139], a[132:135], a[120:123], v[136:139]
ds_read_b64_tr_b16 a[62:63], v69 offset:9216
ds_read_b64_tr_b16 a[64:65], v38 offset:8192
v_mfma_f32_16x16x32_bf16 v[140:143], a[132:135], a[124:127], v[140:143]
buffer_load_dwordx4 v12, s[24:27], s51 offen offset:2048 lds
ds_read_b64_tr_b16 a[66:67], v38 offset:9216
v_mfma_f32_16x16x32_bf16 v[144:147], a[136:139], a[120:123], v[144:147]
ds_read_b64_tr_b16 a[68:69], v70 offset:8192
ds_read_b64_tr_b16 a[70:71], v70 offset:9216
v_mfma_f32_16x16x32_bf16 v[148:151], a[136:139], a[124:127], v[148:151]
ds_read_b64_tr_b16 a[72:73], v39 offset:8192
v_mfma_f32_16x16x32_bf16 v[152:155], a[140:143], a[120:123], v[152:155]
buffer_load_dwordx4 v13, s[24:27], s51 offen offset:3072 lds
ds_read_b64_tr_b16 a[74:75], v39 offset:9216
ds_read_b64_tr_b16 a[76:77], v71 offset:8192
v_mfma_f32_16x16x32_bf16 v[156:159], a[140:143], a[124:127], v[156:159]
ds_read_b64_tr_b16 a[78:79], v71 offset:9216
v_mfma_f32_16x16x32_bf16 v[160:163], a[144:147], a[120:123], v[160:163]
v_mfma_f32_16x16x32_bf16 v[164:167], a[144:147], a[124:127], v[164:167]
v_xor_b32 v4, 32, v30
v_add_u32 v2, 0x3c00, v4
v_add_u32 v3, 0x7800, v30
v_add_u32 v4, 0xb400, v4
v_mfma_f32_16x16x32_bf16 v[168:171], a[148:151], a[120:123], v[168:171]
v_mfma_f32_16x16x32_bf16 v[172:175], a[148:151], a[124:127], v[172:175]
v_mfma_f32_16x16x32_bf16 v[176:179], a[152:155], a[120:123], v[176:179]
s_cmp_lg_u32 s89, 0
s_cbranch_scc1 L_pf9
buffer_load_dword v23, v25, s[16:19], s85 offen
L_pf9:
v_mfma_f32_16x16x32_bf16 v[180:183], a[152:155], a[124:127], v[180:183]
v_mfma_f32_16x16x32_bf16 v[184:187], a[156:159], a[120:123], v[184:187]
v_mfma_f32_16x16x32_bf16 v[188:191], a[156:159], a[124:127], v[188:191]
s_waitcnt lgkmcnt(0)
s_waitcnt vmcnt(8)
s_barrier
v_mfma_f32_16x16x32_bf16 v[128:131], a[8:11], a[0:3], v[128:131]
s_add_u32 m0, s48, 0x8000
s_add_u32 s51, s54, 0
buffer_load_dwordx4 v10, s[24:27], s51 offen offset:0 lds
ds_read_b128 a[80:83], v32 offset:32768
ds_read_b128 a[84:87], v32 offset:34816
v_mfma_f32_16x16x32_bf16 v[132:135], a[8:11], a[4:7], v[132:135]
ds_read_b64_tr_b16 a[88:89], v36 offset:32768
v_mfma_f32_16x16x32_bf16 v[136:139], a[12:15], a[0:3], v[136:139]
ds_read_b64_tr_b16 a[90:91], v36 offset:33792
ds_read_b64_tr_b16 a[92:93], v68 offset:32768
v_mfma_f32_16x16x32_bf16 v[140:143], a[12:15], a[4:7], v[140:143]
buffer_load_dwordx4 v11, s[24:27], s51 offen offset:1024 lds
ds_read_b64_tr_b16 a[94:95], v68 offset:33792
v_mfma_f32_16x16x32_bf16 v[144:147], a[16:19], a[0:3], v[144:147]
ds_read_b64_tr_b16 a[96:97], v37 offset:32768
ds_read_b64_tr_b16 a[98:99], v37 offset:33792
v_mfma_f32_16x16x32_bf16 v[148:151], a[16:19], a[4:7], v[148:151]
ds_read_b64_tr_b16 a[100:101], v69 offset:32768
v_mfma_f32_16x16x32_bf16 v[152:155], a[20:23], a[0:3], v[152:155]
ds_read_b64_tr_b16 a[102:103], v69 offset:33792
ds_read_b64_tr_b16 a[104:105], v38 offset:32768
v_mfma_f32_16x16x32_bf16 v[156:159], a[20:23], a[4:7], v[156:159]
buffer_load_dwordx4 v12, s[24:27], s51 offen offset:2048 lds
ds_read_b64_tr_b16 a[106:107], v38 offset:33792
v_mfma_f32_16x16x32_bf16 v[160:163], a[24:27], a[0:3], v[160:163]
ds_read_b64_tr_b16 a[108:109], v70 offset:32768
ds_read_b64_tr_b16 a[110:111], v70 offset:33792
v_mfma_f32_16x16x32_bf16 v[164:167], a[24:27], a[4:7], v[164:167]
ds_read_b64_tr_b16 a[112:113], v39 offset:32768
v_mfma_f32_16x16x32_bf16 v[168:171], a[28:31], a[0:3], v[168:171]
buffer_load_dwordx4 v13, s[24:27], s51 offen offset:3072 lds
ds_read_b64_tr_b16 a[114:115], v39 offset:33792
ds_read_b64_tr_b16 a[116:117], v71 offset:32768
v_mfma_f32_16x16x32_bf16 v[172:175], a[28:31], a[4:7], v[172:175]
ds_read_b64_tr_b16 a[118:119], v71 offset:33792
v_mfma_f32_16x16x32_bf16 v[176:179], a[32:35], a[0:3], v[176:179]
ds_read_b128 a[120:123], v34 offset:32768
ds_read_b128 a[124:127], v34 offset:34816
v_mfma_f32_16x16x32_bf16 v[180:183], a[32:35], a[4:7], v[180:183]
ds_read_b64_tr_b16 a[128:129], v36 offset:40960
v_mfma_f32_16x16x32_bf16 v[184:187], a[36:39], a[0:3], v[184:187]
s_add_u32 m0, s48, 0x9000
s_add_u32 s51, s54, 4096
buffer_load_dwordx4 v10, s[24:27], s51 offen offset:0 lds
ds_read_b64_tr_b16 a[130:131], v36 offset:41984
ds_read_b64_tr_b16 a[132:133], v68 offset:40960
v_mfma_f32_16x16x32_bf16 v[188:191], a[36:39], a[4:7], v[188:191]
ds_read_b64_tr_b16 a[134:135], v68 offset:41984
v_mfma_f32_16x16x32_bf16 v[128:131], a[48:51], a[40:43], v[128:131]
ds_read_b64_tr_b16 a[136:137], v37 offset:40960
ds_read_b64_tr_b16 a[138:139], v37 offset:41984
v_mfma_f32_16x16x32_bf16 v[132:135], a[48:51], a[44:47], v[132:135]
buffer_load_dwordx4 v11, s[24:27], s51 offen offset:1024 lds
ds_read_b64_tr_b16 a[140:141], v69 offset:40960
v_mfma_f32_16x16x32_bf16 v[136:139], a[52:55], a[40:43], v[136:139]
ds_read_b64_tr_b16 a[142:143], v69 offset:41984
ds_read_b64_tr_b16 a[144:145], v38 offset:40960
v_mfma_f32_16x16x32_bf16 v[140:143], a[52:55], a[44:47], v[140:143]
ds_read_b64_tr_b16 a[146:147], v38 offset:41984
v_mfma_f32_16x16x32_bf16 v[144:147], a[56:59], a[40:43], v[144:147]
ds_read_b64_tr_b16 a[148:149], v70 offset:40960
ds_read_b64_tr_b16 a[150:151], v70 offset:41984
v_mfma_f32_16x16x32_bf16 v[148:151], a[56:59], a[44:47], v[148:151]
buffer_load_dwordx4 v12, s[24:27], s51 offen offset:2048 lds
ds_read_b64_tr_b16 a[152:153], v39 offset:40960
v_mfma_f32_16x16x32_bf16 v[152:155], a[60:63], a[40:43], v[152:155]
ds_read_b64_tr_b16 a[154:155], v39 offset:41984
ds_read_b64_tr_b16 a[156:157], v71 offset:40960
v_mfma_f32_16x16x32_bf16 v[156:159], a[60:63], a[44:47], v[156:159]
ds_read_b64_tr_b16 a[158:159], v71 offset:41984
v_mfma_f32_16x16x32_bf16 v[160:163], a[64:67], a[40:43], v[160:163]
buffer_load_dwordx4 v13, s[24:27], s51 offen offset:3072 lds
v_mfma_f32_16x16x32_bf16 v[164:167], a[64:67], a[44:47], v[164:167]
v_mfma_f32_16x16x32_bf16 v[168:171], a[68:71], a[40:43], v[168:171]
v_mfma_f32_16x16x32_bf16 v[172:175], a[68:71], a[44:47], v[172:175]
v_mfma_f32_16x16x32_bf16 v[176:179], a[72:75], a[40:43], v[176:179]
s_cmp_lg_u32 s89, 1
s_cbranch_scc1 L_pf10
buffer_load_dword v23, v25, s[16:19], s85 offen
L_pf10:
v_mfma_f32_16x16x32_bf16 v[180:183], a[72:75], a[44:47], v[180:183]
v_mfma_f32_16x16x32_bf16 v[184:187], a[76:79], a[40:43], v[184:187]
v_mfma_f32_16x16x32_bf16 v[188:191], a[76:79], a[44:47], v[188:191]
s_waitcnt lgkmcnt(0)
s_barrier
s_waitcnt vmcnt(8)
v_mfma_f32_16x16x32_bf16 v[128:131], a[88:91], a[80:83], v[128:131]
s_add_u32 m0, s48, 0x10000
s_or_b32 s49, s56, 0
s_lshl_b32 s49, s49, 17
s_add_u32 s56, s56, 1
s_and_b32 s56, s56, 7
buffer_load_dwordx4 v30, s[16:19], s49 offen offset:0 lds
v_xor_b32 v29, 0, v28
ds_read_b128 a[192:195], v29 offset:0
v_mfma_f32_16x16x32_bf16 v[132:135], a[88:91], a[84:87], v[132:135]
v_mfma_f32_16x16x32_bf16 v[136:139], a[92:95], a[80:83], v[136:139]
v_mfma_f32_16x16x32_bf16 v[140:143], a[92:95], a[84:87], v[140:143]
buffer_load_dwordx4 v2, s[16:19], s49 offen offset:1024 lds
v_xor_b32 v29, 64, v28
ds_read_b128 a[196:199], v29 offset:0
v_mfma_f32_16x16x32_bf16 v[144:147], a[96:99], a[80:83], v[144:147]
v_mfma_f32_16x16x32_bf16 v[148:151], a[96:99], a[84:87], v[148:151]
v_mfma_f32_16x16x32_bf16 v[152:155], a[100:103], a[80:83], v[152:155]
v_xor_b32 v29, 128, v28
ds_read_b128 a[200:203], v29 offset:0
v_mfma_f32_16x16x32_bf16 v[156:159], a[100:103], a[84:87], v[156:159]
buffer_load_dwordx4 v3, s[16:19], s49 offen offset:2048 lds
v_mfma_f32_16x16x32_bf16 v[160:163], a[104:107], a[80:83], v[160:163]
v_mfma_f32_16x16x32_bf16 v[164:167], a[104:107], a[84:87], v[164:167]
v_xor_b32 v29, 192, v28
ds_read_b128 a[204:207], v29 offset:0
v_mfma_f32_16x16x32_bf16 v[168:171], a[108:111], a[80:83], v[168:171]
buffer_load_dwordx4 v4, s[16:19], s49 offen offset:3072 lds
v_mfma_f32_16x16x32_bf16 v[172:175], a[108:111], a[84:87], v[172:175]
v_mfma_f32_16x16x32_bf16 v[176:179], a[112:115], a[80:83], v[176:179]
v_xor_b32 v29, 0, v28
ds_read_b128 a[208:211], v29 offset:4096
v_mfma_f32_16x16x32_bf16 v[180:183], a[112:115], a[84:87], v[180:183]
v_mfma_f32_16x16x32_bf16 v[184:187], a[116:119], a[80:83], v[184:187]
s_add_u32 m0, s48, 0x11000
s_add_u32 s49, s49, 0x10000
buffer_load_dwordx4 v30, s[16:19], s49 offen offset:0 lds
v_mfma_f32_16x16x32_bf16 v[188:191], a[116:119], a[84:87], v[188:191]
v_xor_b32 v29, 64, v28
ds_read_b128 a[212:215], v29 offset:4096
v_mfma_f32_16x16x32_bf16 v[128:131], a[128:131], a[120:123], v[128:131]
v_mfma_f32_16x16x32_bf16 v[132:135], a[128:131], a[124:127], v[132:135]
buffer_load_dwordx4 v2, s[16:19], s49 offen offset:1024 lds
v_mfma_f32_16x16x32_bf16 v[136:139], a[132:135], a[120:123], v[136:139]
v_xor_b32 v29, 128, v28
ds_read_b128 a[216:219], v29 offset:4096
v_mfma_f32_16x16x32_bf16 v[140:143], a[132:135], a[124:127], v[140:143]
v_mfma_f32_16x16x32_bf16 v[144:147], a[136:139], a[120:123], v[144:147]
v_mfma_f32_16x16x32_bf16 v[148:151], a[136:139], a[124:127], v[148:151]
buffer_load_dwordx4 v3, s[16:19], s49 offen offset:2048 lds
v_xor_b32 v29, 192, v28
ds_read_b128 a[220:223], v29 offset:4096
v_mfma_f32_16x16x32_bf16 v[152:155], a[140:143], a[120:123], v[152:155]
v_mfma_f32_16x16x32_bf16 v[156:159], a[140:143], a[124:127], v[156:159]
v_mfma_f32_16x16x32_bf16 v[160:163], a[144:147], a[120:123], v[160:163]
buffer_load_dwordx4 v4, s[16:19], s49 offen offset:3072 lds
v_mfma_f32_16x16x32_bf16 v[164:167], a[144:147], a[124:127], v[164:167]
v_mfma_f32_16x16x32_bf16 v[168:171], a[148:151], a[120:123], v[168:171]
v_mfma_f32_16x16x32_bf16 v[172:175], a[148:151], a[124:127], v[172:175]
v_mfma_f32_16x16x32_bf16 v[176:179], a[152:155], a[120:123], v[176:179]
s_cmp_lg_u32 s89, 2
s_cbranch_scc1 L_pf11
buffer_load_dword v23, v25, s[16:19], s85 offen
L_pf11:
v_mfma_f32_16x16x32_bf16 v[180:183], a[152:155], a[124:127], v[180:183]
v_mfma_f32_16x16x32_bf16 v[184:187], a[156:159], a[120:123], v[184:187]
v_mfma_f32_16x16x32_bf16 v[188:191], a[156:159], a[124:127], v[188:191]
v_add_u32 v14, 0x10000, v26
s_add_u32 m0, s48, 0x18000
s_or_b32 s49, s56, 0
s_lshl_b32 s49, s49, 17
s_add_u32 s56, s56, 1
s_and_b32 s56, s56, 7
buffer_load_dwordx4 v30, s[16:19], s49 offen offset:0 lds
v_add_u32 v15, 0x10000, v27
v_add_u32 v16, 0x20000, v26
v_add_u32 v17, 0x20000, v27
v_xor_b32 v18, 32, v26
v_xor_b32 v19, 32, v27
v_xor_b32 v20, 32, v14
v_xor_b32 v21, 32, v15
v_xor_b32 v12, 32, v16
v_xor_b32 v13, 32, v17
s_mov_b32 s82, 0x3e0293ee
s_lshl_b32 s45, s5, 4
s_add_u32 s45, s45, s42
s_lshl_b32 s45, s45, 5
s_add_u32 s45, s45, s41
s_lshl_b32 s45, s45, 11
s_nop 1
v_cvt_pk_bf16_f32 v192, v128, v129
buffer_load_dwordx4 v2, s[16:19], s49 offen offset:1024 lds
v_cvt_pk_bf16_f32 v193, v130, v131
v_cvt_pk_bf16_f32 v194, v132, v133
v_cvt_pk_bf16_f32 v195, v134, v135
v_cvt_pk_bf16_f32 v196, v136, v137
v_cvt_pk_bf16_f32 v197, v138, v139
v_cvt_pk_bf16_f32 v198, v140, v141
v_cvt_pk_bf16_f32 v199, v142, v143
buffer_load_dwordx4 v3, s[16:19], s49 offen offset:2048 lds
v_permlane16_swap_b32 v192, v194
v_permlane16_swap_b32 v193, v195
v_cvt_pk_bf16_f32 v200, v144, v145
v_cvt_pk_bf16_f32 v201, v146, v147
v_cvt_pk_bf16_f32 v202, v148, v149
v_cvt_pk_bf16_f32 v203, v150, v151
v_permlane16_swap_b32 v196, v198
v_permlane16_swap_b32 v197, v199
buffer_load_dwordx4 v4, s[16:19], s49 offen offset:3072 lds
v_mfma_f32_32x32x16_bf16 v[224:239], a[160:163], v[192:195], 0
v_cvt_pk_bf16_f32 v204, v152, v153
v_cvt_pk_bf16_f32 v205, v154, v155
v_cvt_pk_bf16_f32 v206, v156, v157
v_cvt_pk_bf16_f32 v207, v158, v159
v_permlane16_swap_b32 v200, v202
v_permlane16_swap_b32 v201, v203
v_mfma_f32_32x32x16_bf16 v[224:239], a[164:167], v[196:199], v[224:239]
s_add_u32 m0, s48, 0x19000
s_add_u32 s49, s49, 0x10000
buffer_load_dwordx4 v30, s[16:19], s49 offen offset:0 lds
v_cvt_pk_bf16_f32 v208, v160, v161
v_cvt_pk_bf16_f32 v209, v162, v163
v_cvt_pk_bf16_f32 v210, v164, v165
v_cvt_pk_bf16_f32 v211, v166, v167
v_permlane16_swap_b32 v204, v206
v_permlane16_swap_b32 v205, v207
v_mfma_f32_32x32x16_bf16 v[224:239], a[168:171], v[200:203], v[224:239]
buffer_load_dwordx4 v2, s[16:19], s49 offen offset:1024 lds
v_cvt_pk_bf16_f32 v212, v168, v169
v_cvt_pk_bf16_f32 v213, v170, v171
v_cvt_pk_bf16_f32 v214, v172, v173
v_cvt_pk_bf16_f32 v215, v174, v175
v_permlane16_swap_b32 v208, v210
v_permlane16_swap_b32 v209, v211
v_mfma_f32_32x32x16_bf16 v[224:239], a[172:175], v[204:207], v[224:239]
v_cvt_pk_bf16_f32 v216, v176, v177
buffer_load_dwordx4 v3, s[16:19], s49 offen offset:2048 lds
v_cvt_pk_bf16_f32 v217, v178, v179
v_cvt_pk_bf16_f32 v218, v180, v181
v_cvt_pk_bf16_f32 v219, v182, v183
v_permlane16_swap_b32 v212, v214
v_permlane16_swap_b32 v213, v215
v_mfma_f32_32x32x16_bf16 v[224:239], a[176:179], v[208:211], v[224:239]
v_cvt_pk_bf16_f32 v220, v184, v185
buffer_load_dwordx4 v4, s[16:19], s49 offen offset:3072 lds
v_cvt_pk_bf16_f32 v221, v186, v187
v_cvt_pk_bf16_f32 v222, v188, v189
v_cvt_pk_bf16_f32 v223, v190, v191
v_permlane16_swap_b32 v216, v218
v_permlane16_swap_b32 v217, v219
v_mfma_f32_32x32x16_bf16 v[224:239], a[180:183], v[212:215], v[224:239]
s_nop 1
v_permlane16_swap_b32 v220, v222
v_permlane16_swap_b32 v221, v223
v_mfma_f32_32x32x16_bf16 v[224:239], a[184:187], v[216:219], v[224:239]
s_nop 0
s_nop 0
v_mfma_f32_32x32x16_bf16 v[224:239], a[188:191], v[220:223], v[224:239]
s_add_u32 m0, s48, 0x20000
s_or_b32 s49, s56, 0
s_lshl_b32 s49, s49, 17
s_add_u32 s56, s56, 1
s_and_b32 s56, s56, 7
buffer_load_dwordx4 v30, s[16:19], s49 offen offset:0 lds
s_waitcnt vmcnt(17)
v_xor_b32 v29, 0, v28
ds_read_b128 a[224:227], v29 offset:32768
v_xor_b32 v29, 64, v28
ds_read_b128 a[228:231], v29 offset:32768
v_xor_b32 v29, 128, v28
ds_read_b128 a[232:235], v29 offset:32768
v_xor_b32 v29, 192, v28
ds_read_b128 a[236:239], v29 offset:32768
v_xor_b32 v29, 0, v28
ds_read_b128 a[240:243], v29 offset:36864
buffer_load_dwordx4 v2, s[16:19], s49 offen offset:1024 lds
v_xor_b32 v29, 64, v28
ds_read_b128 a[244:247], v29 offset:36864
v_xor_b32 v29, 128, v28
ds_read_b128 a[248:251], v29 offset:36864
v_xor_b32 v29, 192, v28
ds_read_b128 a[252:255], v29 offset:36864
v_max3_f32 v240, v224, v225, v226
v_max3_f32 v240, v240, v227, v228
v_max3_f32 v240, v240, v229, v230
v_max3_f32 v240, v240, v231, v232
buffer_load_dwordx4 v3, s[16:19], s49 offen offset:2048 lds
v_max3_f32 v240, v240, v233, v234
v_max3_f32 v240, v240, v235, v236
v_max3_f32 v240, v240, v237, v238
v_max_f32 v240, v240, v239
v_mov_b32 v241, v240
s_nop 1
v_permlane32_swap_b32 v240, v241
s_nop 1
v_max_f32 v240, v240, v241
v_mul_f32 v240, s82, v240
v_fma_f32 v224, v224, s82, -v240
v_fma_f32 v225, v225, s82, -v240
buffer_load_dwordx4 v4, s[16:19], s49 offen offset:3072 lds
v_fma_f32 v226, v226, s82, -v240
v_fma_f32 v227, v227, s82, -v240
v_fma_f32 v228, v228, s82, -v240
v_fma_f32 v229, v229, s82, -v240
v_fma_f32 v230, v230, s82, -v240
v_fma_f32 v231, v231, s82, -v240
v_fma_f32 v232, v232, s82, -v240
s_add_u32 m0, s48, 0x21000
s_add_u32 s49, s49, 0x10000
buffer_load_dwordx4 v30, s[16:19], s49 offen offset:0 lds
v_fma_f32 v233, v233, s82, -v240
v_fma_f32 v234, v234, s82, -v240
v_fma_f32 v235, v235, s82, -v240
v_fma_f32 v236, v236, s82, -v240
v_fma_f32 v237, v237, s82, -v240
v_fma_f32 v238, v238, s82, -v240
buffer_load_dwordx4 v2, s[16:19], s49 offen offset:1024 lds
v_fma_f32 v239, v239, s82, -v240
v_exp_f32 v224, v224
v_exp_f32 v225, v225
v_exp_f32 v226, v226
v_exp_f32 v227, v227
v_exp_f32 v228, v228
v_exp_f32 v229, v229
buffer_load_dwordx4 v3, s[16:19], s49 offen offset:2048 lds
v_exp_f32 v230, v230
v_exp_f32 v231, v231
v_exp_f32 v232, v232
v_exp_f32 v233, v233
v_exp_f32 v234, v234
v_exp_f32 v235, v235
buffer_load_dwordx4 v4, s[16:19], s49 offen offset:3072 lds
v_exp_f32 v236, v236
v_exp_f32 v237, v237
v_exp_f32 v238, v238
v_exp_f32 v239, v239
v_add_f32 v240, v224, v225
v_add_f32 v241, v226, v227
v_add_f32 v240, v240, v228
v_add_f32 v241, v241, v229
v_add_f32 v240, v240, v230
v_add_f32 v241, v241, v231
v_add_f32 v240, v240, v232
v_add_f32 v241, v241, v233
v_add_f32 v240, v240, v234
v_add_f32 v241, v241, v235
v_add_f32 v240, v240, v236
v_add_f32 v241, v241, v237
v_add_f32 v240, v240, v238
v_add_f32 v241, v241, v239
v_add_f32 v240, v240, v241
v_mov_b32 v241, v240
s_nop 1
v_permlane32_swap_b32 v240, v241
s_nop 1
v_add_f32 v240, v240, v241
v_rcp_f32 v240, v240
s_nop 0
v_mul_f32 v224, v224, v240
v_mul_f32 v225, v225, v240
v_mul_f32 v226, v226, v240
v_mul_f32 v227, v227, v240
v_mul_f32 v228, v228, v240
v_mul_f32 v229, v229, v240
v_mul_f32 v230, v230, v240
v_mul_f32 v231, v231, v240
v_mul_f32 v232, v232, v240
v_mul_f32 v233, v233, v240
v_mul_f32 v234, v234, v240
v_mul_f32 v235, v235, v240
v_mul_f32 v236, v236, v240
v_mul_f32 v237, v237, v240
v_mul_f32 v238, v238, v240
v_mul_f32 v239, v239, v240
v_cvt_pk_bf16_f32 v240, v224, v225
v_cvt_pk_bf16_f32 v241, v226, v227
v_cvt_pk_bf16_f32 v242, v228, v229
v_cvt_pk_bf16_f32 v243, v230, v231
v_cvt_pk_bf16_f32 v244, v232, v233
v_cvt_pk_bf16_f32 v245, v234, v235
v_cvt_pk_bf16_f32 v246, v236, v237
v_cvt_pk_bf16_f32 v247, v238, v239
buffer_store_dwordx4 v[240:243], v31, s[36:39], s45 offen sc1
buffer_store_dwordx4 v[244:247], v31, s[36:39], s45 offen offset:1024 sc1
s_waitcnt vmcnt(18)
ds_read_b64_tr_b16 a[0:1], v14 offset:0
ds_read_b64_tr_b16 a[2:3], v14 offset:512
ds_read_b64_tr_b16 a[4:5], v20 offset:0
ds_read_b64_tr_b16 a[6:7], v20 offset:512
ds_read_b64_tr_b16 a[8:9], v15 offset:0
ds_read_b64_tr_b16 a[10:11], v15 offset:512
ds_read_b64_tr_b16 a[12:13], v21 offset:0
ds_read_b64_tr_b16 a[14:15], v21 offset:512
ds_read_b64_tr_b16 a[16:17], v14 offset:4096
ds_read_b64_tr_b16 a[18:19], v14 offset:4608
ds_read_b64_tr_b16 a[20:21], v20 offset:4096
ds_read_b64_tr_b16 a[22:23], v20 offset:4608
ds_read_b64_tr_b16 a[24:25], v15 offset:4096
ds_read_b64_tr_b16 a[26:27], v15 offset:4608
ds_read_b64_tr_b16 a[28:29], v21 offset:4096
ds_read_b64_tr_b16 a[30:31], v21 offset:4608
s_lshl_b32 s57, s5, 2
s_add_u32 s57, s57, s40
s_lshl_b32 s57, s57, 2
s_add_u32 s57, s57, s3
s_lshl_b32 s57, s57, 6
s_add_u32 s57, s57, s44
s_lshl_b32 s57, s57, 2
s_add_u32 s57, s57, 0x400000
s_lshl_b32 s58, s5, 2
s_lshr_b32 s7, s44, 1
s_add_u32 s58, s58, s7
s_lshl_b32 s58, s58, 2
s_add_u32 s58, s58, s6
s_lshl_b32 s58, s58, 8
s_add_u32 s58, s58, 0x400000
s_lshl_b32 s59, s5, 3
s_add_u32 s59, s59, s44
s_lshl_b32 s59, s59, 3
s_add_u32 s59, s59, s6
s_lshl_b32 s59, s59, 14
s_lshl_b32 s7, s81, 16
s_add_u32 s59, s59, s7
s_lshl_b32 s57, s5, 3
s_lshr_b32 s7, s42, 1
s_add_u32 s57, s57, s7
s_lshl_b32 s57, s57, 2
s_add_u32 s57, s57, s3
s_lshl_b32 s57, s57, 6
s_and_b32 s7, s42, 1
s_lshl_b32 s7, s7, 3
s_add_u32 s57, s57, s7
s_add_u32 s57, s57, s44
s_lshl_b32 s57, s57, 2
s_add_u32 s57, s57, 0x400000
s_lshl_b32 s58, s5, 3
s_add_u32 s58, s58, s44
s_lshl_b32 s58, s58, 2
s_add_u32 s58, s58, s6
s_lshl_b32 s58, s58, 8
s_add_u32 s58, s58, 0x400000
v_mov_b32 v1, 0
v_mov_b32 v5, s90
v_and_b32 v7, 15, v0
v_lshlrev_b32 v7, 2, v7
s_waitcnt lgkmcnt(0)
s_waitcnt vmcnt(10)
v_mfma_f32_16x16x32_bf16 v[128:131], a[192:195], a[0:3], 0
s_add_u32 m0, s48, 0x0
s_or_b32 s49, s56, 0
s_lshl_b32 s49, s49, 17
s_add_u32 s56, s56, 1
s_and_b32 s56, s56, 7
buffer_load_dwordx4 v30, s[16:19], s49 offen offset:0 lds
ds_read_b64_tr_b16 a[32:33], v14 offset:32768
v_mfma_f32_16x16x32_bf16 v[136:139], a[208:211], a[0:3], 0
ds_read_b64_tr_b16 a[34:35], v14 offset:33280
v_mfma_f32_16x16x32_bf16 v[160:163], a[224:227], a[0:3], 0
ds_read_b64_tr_b16 a[36:37], v20 offset:32768
v_mfma_f32_16x16x32_bf16 v[168:171], a[240:243], a[0:3], 0
buffer_load_dwordx4 v2, s[16:19], s49 offen offset:1024 lds
ds_read_b64_tr_b16 a[38:39], v20 offset:33280
v_mfma_f32_16x16x32_bf16 v[132:135], a[192:195], a[4:7], 0
v_mfma_f32_16x16x32_bf16 v[140:143], a[208:211], a[4:7], 0
ds_read_b64_tr_b16 a[40:41], v15 offset:32768
v_mfma_f32_16x16x32_bf16 v[164:167], a[224:227], a[4:7], 0
ds_read_b64_tr_b16 a[42:43], v15 offset:33280
v_mfma_f32_16x16x32_bf16 v[172:175], a[240:243], a[4:7], 0
buffer_load_dwordx4 v3, s[16:19], s49 offen offset:2048 lds
ds_read_b64_tr_b16 a[44:45], v21 offset:32768
v_mfma_f32_16x16x32_bf16 v[144:147], a[192:195], a[8:11], 0
ds_read_b64_tr_b16 a[46:47], v21 offset:33280
v_mfma_f32_16x16x32_bf16 v[152:155], a[208:211], a[8:11], 0
v_mfma_f32_16x16x32_bf16 v[176:179], a[224:227], a[8:11], 0
buffer_load_dwordx4 v4, s[16:19], s49 offen offset:3072 lds
ds_read_b64_tr_b16 a[48:49], v14 offset:36864
v_mfma_f32_16x16x32_bf16 v[184:187], a[240:243], a[8:11], 0
ds_read_b64_tr_b16 a[50:51], v14 offset:37376
v_mfma_f32_16x16x32_bf16 v[148:151], a[192:195], a[12:15], 0
ds_read_b64_tr_b16 a[52:53], v20 offset:36864
v_mfma_f32_16x16x32_bf16 v[156:159], a[208:211], a[12:15], 0
ds_read_b64_tr_b16 a[54:55], v20 offset:37376
v_mfma_f32_16x16x32_bf16 v[180:183], a[224:227], a[12:15], 0
s_add_u32 m0, s48, 0x1000
s_add_u32 s49, s49, 0x10000
buffer_load_dwordx4 v30, s[16:19], s49 offen offset:0 lds
v_mfma_f32_16x16x32_bf16 v[188:191], a[240:243], a[12:15], 0
ds_read_b64_tr_b16 a[56:57], v15 offset:36864
v_mfma_f32_16x16x32_bf16 v[128:131], a[196:199], a[16:19], v[128:131]
ds_read_b64_tr_b16 a[58:59], v15 offset:37376
v_mfma_f32_16x16x32_bf16 v[136:139], a[212:215], a[16:19], v[136:139]
buffer_load_dwordx4 v2, s[16:19], s49 offen offset:1024 lds
ds_read_b64_tr_b16 a[60:61], v21 offset:36864
v_mfma_f32_16x16x32_bf16 v[160:163], a[228:231], a[16:19], v[160:163]
ds_read_b64_tr_b16 a[62:63], v21 offset:37376
v_mfma_f32_16x16x32_bf16 v[168:171], a[244:247], a[16:19], v[168:171]
v_mfma_f32_16x16x32_bf16 v[132:135], a[196:199], a[20:23], v[132:135]
v_mfma_f32_16x16x32_bf16 v[140:143], a[212:215], a[20:23], v[140:143]
buffer_load_dwordx4 v3, s[16:19], s49 offen offset:2048 lds
v_mfma_f32_16x16x32_bf16 v[164:167], a[228:231], a[20:23], v[164:167]
v_mfma_f32_16x16x32_bf16 v[172:175], a[244:247], a[20:23], v[172:175]
v_mfma_f32_16x16x32_bf16 v[144:147], a[196:199], a[24:27], v[144:147]
buffer_load_dwordx4 v4, s[16:19], s49 offen offset:3072 lds
v_mfma_f32_16x16x32_bf16 v[152:155], a[212:215], a[24:27], v[152:155]
v_mfma_f32_16x16x32_bf16 v[176:179], a[228:231], a[24:27], v[176:179]
v_mfma_f32_16x16x32_bf16 v[184:187], a[244:247], a[24:27], v[184:187]
v_mfma_f32_16x16x32_bf16 v[148:151], a[196:199], a[28:31], v[148:151]
s_waitcnt vmcnt(8)
s_mov_b64 exec, 1
buffer_store_dword v5, v1, s[36:39], s57 offen sc1
s_mov_b64 exec, -1
s_cmp_lg_u32 s89, 3
s_cbranch_scc1 L_pf12
buffer_load_dword v23, v25, s[16:19], s85 offen
L_pf12:
v_mfma_f32_16x16x32_bf16 v[156:159], a[212:215], a[28:31], v[156:159]
v_mfma_f32_16x16x32_bf16 v[180:183], a[228:231], a[28:31], v[180:183]
v_mfma_f32_16x16x32_bf16 v[188:191], a[244:247], a[28:31], v[188:191]
s_waitcnt lgkmcnt(0)
s_waitcnt vmcnt(11)
v_mfma_f32_16x16x32_bf16 v[128:131], a[200:203], a[32:35], v[128:131]
s_add_u32 m0, s48, 0x8000
s_or_b32 s49, s56, 0
s_lshl_b32 s49, s49, 17
s_add_u32 s56, s56, 1
s_and_b32 s56, s56, 7
buffer_load_dwordx4 v30, s[16:19], s49 offen offset:0 lds
ds_read_b64_tr_b16 a[0:1], v16 offset:0
v_mfma_f32_16x16x32_bf16 v[136:139], a[216:219], a[32:35], v[136:139]
ds_read_b64_tr_b16 a[2:3], v16 offset:512
v_mfma_f32_16x16x32_bf16 v[160:163], a[232:235], a[32:35], v[160:163]
ds_read_b64_tr_b16 a[4:5], v12 offset:0
v_mfma_f32_16x16x32_bf16 v[168:171], a[248:251], a[32:35], v[168:171]
buffer_load_dwordx4 v2, s[16:19], s49 offen offset:1024 lds
ds_read_b64_tr_b16 a[6:7], v12 offset:512
v_mfma_f32_16x16x32_bf16 v[132:135], a[200:203], a[36:39], v[132:135]
v_mfma_f32_16x16x32_bf16 v[140:143], a[216:219], a[36:39], v[140:143]
ds_read_b64_tr_b16 a[8:9], v17 offset:0
v_mfma_f32_16x16x32_bf16 v[164:167], a[232:235], a[36:39], v[164:167]
ds_read_b64_tr_b16 a[10:11], v17 offset:512
v_mfma_f32_16x16x32_bf16 v[172:175], a[248:251], a[36:39], v[172:175]
buffer_load_dwordx4 v3, s[16:19], s49 offen offset:2048 lds
ds_read_b64_tr_b16 a[12:13], v13 offset:0
v_mfma_f32_16x16x32_bf16 v[144:147], a[200:203], a[40:43], v[144:147]
ds_read_b64_tr_b16 a[14:15], v13 offset:512
v_mfma_f32_16x16x32_bf16 v[152:155], a[216:219], a[40:43], v[152:155]
v_mfma_f32_16x16x32_bf16 v[176:179], a[232:235], a[40:43], v[176:179]
buffer_load_dwordx4 v4, s[16:19], s49 offen offset:3072 lds
ds_read_b64_tr_b16 a[16:17], v16 offset:4096
v_mfma_f32_16x16x32_bf16 v[184:187], a[248:251], a[40:43], v[184:187]
ds_read_b64_tr_b16 a[18:19], v16 offset:4608
v_mfma_f32_16x16x32_bf16 v[148:151], a[200:203], a[44:47], v[148:151]
ds_read_b64_tr_b16 a[20:21], v12 offset:4096
v_mfma_f32_16x16x32_bf16 v[156:159], a[216:219], a[44:47], v[156:159]
ds_read_b64_tr_b16 a[22:23], v12 offset:4608
v_mfma_f32_16x16x32_bf16 v[180:183], a[232:235], a[44:47], v[180:183]
s_add_u32 m0, s48, 0x9000
s_add_u32 s49, s49, 0x10000
buffer_load_dwordx4 v30, s[16:19], s49 offen offset:0 lds
v_mfma_f32_16x16x32_bf16 v[188:191], a[248:251], a[44:47], v[188:191]
ds_read_b64_tr_b16 a[24:25], v17 offset:4096
v_mfma_f32_16x16x32_bf16 v[128:131], a[204:207], a[48:51], v[128:131]
ds_read_b64_tr_b16 a[26:27], v17 offset:4608
v_mfma_f32_16x16x32_bf16 v[136:139], a[220:223], a[48:51], v[136:139]
buffer_load_dwordx4 v2, s[16:19], s49 offen offset:1024 lds
ds_read_b64_tr_b16 a[28:29], v13 offset:4096
v_mfma_f32_16x16x32_bf16 v[160:163], a[236:239], a[48:51], v[160:163]
ds_read_b64_tr_b16 a[30:31], v13 offset:4608
v_mfma_f32_16x16x32_bf16 v[168:171], a[252:255], a[48:51], v[168:171]
v_mfma_f32_16x16x32_bf16 v[132:135], a[204:207], a[52:55], v[132:135]
v_mfma_f32_16x16x32_bf16 v[140:143], a[220:223], a[52:55], v[140:143]
buffer_load_dwordx4 v3, s[16:19], s49 offen offset:2048 lds
v_mfma_f32_16x16x32_bf16 v[164:167], a[236:239], a[52:55], v[164:167]
v_mfma_f32_16x16x32_bf16 v[172:175], a[252:255], a[52:55], v[172:175]
v_mfma_f32_16x16x32_bf16 v[144:147], a[204:207], a[56:59], v[144:147]
buffer_load_dwordx4 v4, s[16:19], s49 offen offset:3072 lds
v_mfma_f32_16x16x32_bf16 v[152:155], a[220:223], a[56:59], v[152:155]
v_mfma_f32_16x16x32_bf16 v[176:179], a[236:239], a[56:59], v[176:179]
v_mfma_f32_16x16x32_bf16 v[184:187], a[252:255], a[56:59], v[184:187]
v_mfma_f32_16x16x32_bf16 v[148:151], a[204:207], a[60:63], v[148:151]
s_cmp_lg_u32 s89, 4
s_cbranch_scc1 L_pf13
buffer_load_dword v23, v25, s[16:19], s85 offen
L_pf13:
v_mfma_f32_16x16x32_bf16 v[156:159], a[220:223], a[60:63], v[156:159]
v_mfma_f32_16x16x32_bf16 v[180:183], a[236:239], a[60:63], v[180:183]
v_mfma_f32_16x16x32_bf16 v[188:191], a[252:255], a[60:63], v[188:191]
s_waitcnt lgkmcnt(0)
s_waitcnt vmcnt(9)
v_mfma_f32_16x16x32_bf16 v[192:195], a[192:195], a[0:3], 0
s_add_u32 m0, s48, 0x10000
s_or_b32 s49, s56, 0
s_lshl_b32 s49, s49, 17
s_add_u32 s56, s56, 1
s_and_b32 s56, s56, 7
buffer_load_dwordx4 v30, s[16:19], s49 offen offset:0 lds
ds_read_b64_tr_b16 a[32:33], v26 offset:0
v_mfma_f32_16x16x32_bf16 v[200:203], a[208:211], a[0:3], 0
ds_read_b64_tr_b16 a[34:35], v26 offset:512
v_mfma_f32_16x16x32_bf16 v[224:227], a[224:227], a[0:3], 0
ds_read_b64_tr_b16 a[36:37], v18 offset:0
v_mfma_f32_16x16x32_bf16 v[232:235], a[240:243], a[0:3], 0
buffer_load_dwordx4 v2, s[16:19], s49 offen offset:1024 lds
ds_read_b64_tr_b16 a[38:39], v18 offset:512
v_mfma_f32_16x16x32_bf16 v[196:199], a[192:195], a[4:7], 0
v_cvt_pk_bf16_f32 v32, v128, v129
v_mfma_f32_16x16x32_bf16 v[204:207], a[208:211], a[4:7], 0
ds_read_b64_tr_b16 a[40:41], v27 offset:0
v_cvt_pk_bf16_f32 v33, v130, v131
v_mfma_f32_16x16x32_bf16 v[228:231], a[224:227], a[4:7], 0
ds_read_b64_tr_b16 a[42:43], v27 offset:512
v_cvt_pk_bf16_f32 v34, v132, v133
v_mfma_f32_16x16x32_bf16 v[236:239], a[240:243], a[4:7], 0
buffer_load_dwordx4 v3, s[16:19], s49 offen offset:2048 lds
ds_read_b64_tr_b16 a[44:45], v19 offset:0
v_cvt_pk_bf16_f32 v35, v134, v135
v_mfma_f32_16x16x32_bf16 v[208:211], a[192:195], a[8:11], 0
ds_read_b64_tr_b16 a[46:47], v19 offset:512
v_cvt_pk_bf16_f32 v36, v136, v137
v_mfma_f32_16x16x32_bf16 v[216:219], a[208:211], a[8:11], 0
v_cvt_pk_bf16_f32 v37, v138, v139
v_mfma_f32_16x16x32_bf16 v[240:243], a[224:227], a[8:11], 0
buffer_load_dwordx4 v4, s[16:19], s49 offen offset:3072 lds
ds_read_b64_tr_b16 a[48:49], v26 offset:4096
v_cvt_pk_bf16_f32 v38, v140, v141
v_mfma_f32_16x16x32_bf16 v[248:251], a[240:243], a[8:11], 0
ds_read_b64_tr_b16 a[50:51], v26 offset:4608
v_cvt_pk_bf16_f32 v39, v142, v143
v_mfma_f32_16x16x32_bf16 v[212:215], a[192:195], a[12:15], 0
ds_read_b64_tr_b16 a[52:53], v18 offset:4096
v_cvt_pk_bf16_f32 v40, v144, v145
v_mfma_f32_16x16x32_bf16 v[220:223], a[208:211], a[12:15], 0
ds_read_b64_tr_b16 a[54:55], v18 offset:4608
v_cvt_pk_bf16_f32 v41, v146, v147
v_mfma_f32_16x16x32_bf16 v[244:247], a[224:227], a[12:15], 0
s_add_u32 m0, s48, 0x11000
s_add_u32 s49, s49, 0x10000
buffer_load_dwordx4 v30, s[16:19], s49 offen offset:0 lds
v_cvt_pk_bf16_f32 v42, v148, v149
v_mfma_f32_16x16x32_bf16 v[252:255], a[240:243], a[12:15], 0
ds_read_b64_tr_b16 a[56:57], v27 offset:4096
v_cvt_pk_bf16_f32 v43, v150, v151
v_mfma_f32_16x16x32_bf16 v[192:195], a[196:199], a[16:19], v[192:195]
ds_read_b64_tr_b16 a[58:59], v27 offset:4608
v_cvt_pk_bf16_f32 v44, v152, v153
v_mfma_f32_16x16x32_bf16 v[200:203], a[212:215], a[16:19], v[200:203]
buffer_load_dwordx4 v2, s[16:19], s49 offen offset:1024 lds
ds_read_b64_tr_b16 a[60:61], v19 offset:4096
v_cvt_pk_bf16_f32 v45, v154, v155
v_mfma_f32_16x16x32_bf16 v[224:227], a[228:231], a[16:19], v[224:227]
ds_read_b64_tr_b16 a[62:63], v19 offset:4608
v_cvt_pk_bf16_f32 v46, v156, v157
v_mfma_f32_16x16x32_bf16 v[232:235], a[244:247], a[16:19], v[232:235]
v_cvt_pk_bf16_f32 v47, v158, v159
v_mfma_f32_16x16x32_bf16 v[196:199], a[196:199], a[20:23], v[196:199]
v_permlane16_swap_b32 v32, v34
v_mfma_f32_16x16x32_bf16 v[204:207], a[212:215], a[20:23], v[204:207]
buffer_load_dwordx4 v3, s[16:19], s49 offen offset:2048 lds
v_permlane16_swap_b32 v33, v35
v_mfma_f32_16x16x32_bf16 v[228:231], a[228:231], a[20:23], v[228:231]
v_permlane16_swap_b32 v36, v38
v_mfma_f32_16x16x32_bf16 v[236:239], a[244:247], a[20:23], v[236:239]
v_permlane16_swap_b32 v37, v39
v_mfma_f32_16x16x32_bf16 v[208:211], a[196:199], a[24:27], v[208:211]
buffer_load_dwordx4 v4, s[16:19], s49 offen offset:3072 lds
v_permlane16_swap_b32 v40, v42
v_mfma_f32_16x16x32_bf16 v[216:219], a[212:215], a[24:27], v[216:219]
v_permlane16_swap_b32 v41, v43
v_mfma_f32_16x16x32_bf16 v[240:243], a[228:231], a[24:27], v[240:243]
v_permlane16_swap_b32 v44, v46
v_mfma_f32_16x16x32_bf16 v[248:251], a[244:247], a[24:27], v[248:251]
v_permlane16_swap_b32 v45, v47
v_mfma_f32_16x16x32_bf16 v[212:215], a[196:199], a[28:31], v[212:215]
s_cmp_lg_u32 s89, 5
s_cbranch_scc1 L_pf14
buffer_load_dword v23, v25, s[16:19], s85 offen
L_pf14:
v_mfma_f32_16x16x32_bf16 v[220:223], a[212:215], a[28:31], v[220:223]
v_mfma_f32_16x16x32_bf16 v[244:247], a[228:231], a[28:31], v[244:247]
v_mfma_f32_16x16x32_bf16 v[252:255], a[244:247], a[28:31], v[252:255]
s_waitcnt lgkmcnt(0)
s_waitcnt vmcnt(8)
v_mfma_f32_16x16x32_bf16 v[192:195], a[200:203], a[32:35], v[192:195]
s_add_u32 m0, s48, 0x18000
s_or_b32 s49, s56, 0
s_lshl_b32 s49, s49, 17
s_add_u32 s56, s56, 1
s_and_b32 s56, s56, 7
buffer_load_dwordx4 v30, s[16:19], s49 offen offset:0 lds
ds_read_b64_tr_b16 a[0:1], v26 offset:32768
v_cvt_pk_bf16_f32 v48, v160, v161
v_mfma_f32_16x16x32_bf16 v[200:203], a[216:219], a[32:35], v[200:203]
ds_read_b64_tr_b16 a[2:3], v26 offset:33280
v_cvt_pk_bf16_f32 v49, v162, v163
v_mfma_f32_16x16x32_bf16 v[224:227], a[232:235], a[32:35], v[224:227]
ds_read_b64_tr_b16 a[4:5], v18 offset:32768
v_cvt_pk_bf16_f32 v50, v164, v165
v_mfma_f32_16x16x32_bf16 v[232:235], a[248:251], a[32:35], v[232:235]
buffer_load_dwordx4 v2, s[16:19], s49 offen offset:1024 lds
ds_read_b64_tr_b16 a[6:7], v18 offset:33280
v_cvt_pk_bf16_f32 v51, v166, v167
v_mfma_f32_16x16x32_bf16 v[196:199], a[200:203], a[36:39], v[196:199]
v_cvt_pk_bf16_f32 v52, v168, v169
v_mfma_f32_16x16x32_bf16 v[204:207], a[216:219], a[36:39], v[204:207]
ds_read_b64_tr_b16 a[8:9], v27 offset:32768
v_cvt_pk_bf16_f32 v53, v170, v171
v_mfma_f32_16x16x32_bf16 v[228:231], a[232:235], a[36:39], v[228:231]
ds_read_b64_tr_b16 a[10:11], v27 offset:33280
v_mfma_f32_16x16x32_bf16 v[236:239], a[248:251], a[36:39], v[236:239]
buffer_load_dwordx4 v3, s[16:19], s49 offen offset:2048 lds
ds_read_b64_tr_b16 a[12:13], v19 offset:32768
v_cvt_pk_bf16_f32 v54, v172, v173
v_mfma_f32_16x16x32_bf16 v[208:211], a[200:203], a[40:43], v[208:211]
ds_read_b64_tr_b16 a[14:15], v19 offset:33280
v_cvt_pk_bf16_f32 v55, v174, v175
v_mfma_f32_16x16x32_bf16 v[216:219], a[216:219], a[40:43], v[216:219]
v_cvt_pk_bf16_f32 v56, v176, v177
v_mfma_f32_16x16x32_bf16 v[240:243], a[232:235], a[40:43], v[240:243]
buffer_load_dwordx4 v4, s[16:19], s49 offen offset:3072 lds
ds_read_b64_tr_b16 a[16:17], v26 offset:36864
v_cvt_pk_bf16_f32 v57, v178, v179
v_mfma_f32_16x16x32_bf16 v[248:251], a[248:251], a[40:43], v[248:251]
ds_read_b64_tr_b16 a[18:19], v26 offset:37376
v_cvt_pk_bf16_f32 v58, v180, v181
v_mfma_f32_16x16x32_bf16 v[212:215], a[200:203], a[44:47], v[212:215]
ds_read_b64_tr_b16 a[20:21], v18 offset:36864
v_cvt_pk_bf16_f32 v59, v182, v183
v_mfma_f32_16x16x32_bf16 v[220:223], a[216:219], a[44:47], v[220:223]
ds_read_b64_tr_b16 a[22:23], v18 offset:37376
v_mfma_f32_16x16x32_bf16 v[244:247], a[232:235], a[44:47], v[244:247]
s_add_u32 m0, s48, 0x19000
s_add_u32 s49, s49, 0x10000
buffer_load_dwordx4 v30, s[16:19], s49 offen offset:0 lds
v_cvt_pk_bf16_f32 v60, v184, v185
v_mfma_f32_16x16x32_bf16 v[252:255], a[248:251], a[44:47], v[252:255]
ds_read_b64_tr_b16 a[24:25], v27 offset:36864
v_cvt_pk_bf16_f32 v61, v186, v187
v_mfma_f32_16x16x32_bf16 v[192:195], a[204:207], a[48:51], v[192:195]
ds_read_b64_tr_b16 a[26:27], v27 offset:37376
v_cvt_pk_bf16_f32 v62, v188, v189
v_mfma_f32_16x16x32_bf16 v[200:203], a[220:223], a[48:51], v[200:203]
buffer_load_dwordx4 v2, s[16:19], s49 offen offset:1024 lds
ds_read_b64_tr_b16 a[28:29], v19 offset:36864
v_cvt_pk_bf16_f32 v63, v190, v191
v_mfma_f32_16x16x32_bf16 v[224:227], a[236:239], a[48:51], v[224:227]
ds_read_b64_tr_b16 a[30:31], v19 offset:37376
v_permlane16_swap_b32 v48, v50
v_mfma_f32_16x16x32_bf16 v[232:235], a[252:255], a[48:51], v[232:235]
v_permlane16_swap_b32 v49, v51
v_mfma_f32_16x16x32_bf16 v[196:199], a[204:207], a[52:55], v[196:199]
v_mfma_f32_16x16x32_bf16 v[204:207], a[220:223], a[52:55], v[204:207]
buffer_load_dwordx4 v3, s[16:19], s49 offen offset:2048 lds
v_permlane16_swap_b32 v52, v54
v_mfma_f32_16x16x32_bf16 v[228:231], a[236:239], a[52:55], v[228:231]
v_permlane16_swap_b32 v53, v55
v_mfma_f32_16x16x32_bf16 v[236:239], a[252:255], a[52:55], v[236:239]
v_permlane16_swap_b32 v56, v58
v_mfma_f32_16x16x32_bf16 v[208:211], a[204:207], a[56:59], v[208:211]
buffer_load_dwordx4 v4, s[16:19], s49 offen offset:3072 lds
v_permlane16_swap_b32 v57, v59
v_mfma_f32_16x16x32_bf16 v[216:219], a[220:223], a[56:59], v[216:219]
v_permlane16_swap_b32 v60, v62
v_mfma_f32_16x16x32_bf16 v[240:243], a[236:239], a[56:59], v[240:243]
v_permlane16_swap_b32 v61, v63
v_mfma_f32_16x16x32_bf16 v[248:251], a[252:255], a[56:59], v[248:251]
v_mfma_f32_16x16x32_bf16 v[212:215], a[204:207], a[60:63], v[212:215]
s_cmp_lg_u32 s89, 6
s_cbranch_scc1 L_pf15
buffer_load_dword v23, v25, s[16:19], s85 offen
L_pf15:
v_mfma_f32_16x16x32_bf16 v[220:223], a[220:223], a[60:63], v[220:223]
v_mfma_f32_16x16x32_bf16 v[244:247], a[236:239], a[60:63], v[244:247]
v_mfma_f32_16x16x32_bf16 v[252:255], a[252:255], a[60:63], v[252:255]
s_waitcnt lgkmcnt(0)
s_waitcnt vmcnt(8)
v_mfma_f32_16x16x32_bf16 v[128:131], a[192:195], a[0:3], 0
s_add_u32 m0, s48, 0x20000
s_or_b32 s49, s56, 0
s_lshl_b32 s49, s49, 17
s_add_u32 s56, s56, 1
s_and_b32 s56, s56, 7
buffer_load_dwordx4 v30, s[16:19], s49 offen offset:0 lds
ds_read_b64_tr_b16 a[32:33], v14 offset:0
v_mfma_f32_16x16x32_bf16 v[136:139], a[208:211], a[0:3], 0
ds_read_b64_tr_b16 a[34:35], v14 offset:512
v_mfma_f32_16x16x32_bf16 v[160:163], a[224:227], a[0:3], 0
ds_read_b64_tr_b16 a[36:37], v20 offset:0
v_mfma_f32_16x16x32_bf16 v[168:171], a[240:243], a[0:3], 0
buffer_load_dwordx4 v2, s[16:19], s49 offen offset:1024 lds
ds_read_b64_tr_b16 a[38:39], v20 offset:512
v_mfma_f32_16x16x32_bf16 v[132:135], a[192:195], a[4:7], 0
v_cvt_pk_bf16_f32 v64, v192, v193
v_mfma_f32_16x16x32_bf16 v[140:143], a[208:211], a[4:7], 0
ds_read_b64_tr_b16 a[40:41], v15 offset:0
v_cvt_pk_bf16_f32 v65, v194, v195
v_mfma_f32_16x16x32_bf16 v[164:167], a[224:227], a[4:7], 0
ds_read_b64_tr_b16 a[42:43], v15 offset:512
v_cvt_pk_bf16_f32 v66, v196, v197
v_mfma_f32_16x16x32_bf16 v[172:175], a[240:243], a[4:7], 0
buffer_load_dwordx4 v3, s[16:19], s49 offen offset:2048 lds
ds_read_b64_tr_b16 a[44:45], v21 offset:0
v_cvt_pk_bf16_f32 v67, v198, v199
v_mfma_f32_16x16x32_bf16 v[144:147], a[192:195], a[8:11], 0
ds_read_b64_tr_b16 a[46:47], v21 offset:512
v_cvt_pk_bf16_f32 v68, v200, v201
v_mfma_f32_16x16x32_bf16 v[152:155], a[208:211], a[8:11], 0
v_cvt_pk_bf16_f32 v69, v202, v203
v_mfma_f32_16x16x32_bf16 v[176:179], a[224:227], a[8:11], 0
buffer_load_dwordx4 v4, s[16:19], s49 offen offset:3072 lds
ds_read_b64_tr_b16 a[48:49], v14 offset:4096
v_cvt_pk_bf16_f32 v70, v204, v205
v_mfma_f32_16x16x32_bf16 v[184:187], a[240:243], a[8:11], 0
ds_read_b64_tr_b16 a[50:51], v14 offset:4608
v_cvt_pk_bf16_f32 v71, v206, v207
v_mfma_f32_16x16x32_bf16 v[148:151], a[192:195], a[12:15], 0
ds_read_b64_tr_b16 a[52:53], v20 offset:4096
v_cvt_pk_bf16_f32 v72, v208, v209
v_mfma_f32_16x16x32_bf16 v[156:159], a[208:211], a[12:15], 0
ds_read_b64_tr_b16 a[54:55], v20 offset:4608
v_cvt_pk_bf16_f32 v73, v210, v211
v_mfma_f32_16x16x32_bf16 v[180:183], a[224:227], a[12:15], 0
s_add_u32 m0, s48, 0x21000
s_add_u32 s49, s49, 0x10000
buffer_load_dwordx4 v30, s[16:19], s49 offen offset:0 lds
v_cvt_pk_bf16_f32 v74, v212, v213
v_mfma_f32_16x16x32_bf16 v[188:191], a[240:243], a[12:15], 0
ds_read_b64_tr_b16 a[56:57], v15 offset:4096
v_cvt_pk_bf16_f32 v75, v214, v215
v_mfma_f32_16x16x32_bf16 v[128:131], a[196:199], a[16:19], v[128:131]
ds_read_b64_tr_b16 a[58:59], v15 offset:4608
v_cvt_pk_bf16_f32 v76, v216, v217
v_mfma_f32_16x16x32_bf16 v[136:139], a[212:215], a[16:19], v[136:139]
buffer_load_dwordx4 v2, s[16:19], s49 offen offset:1024 lds
ds_read_b64_tr_b16 a[60:61], v21 offset:4096
v_cvt_pk_bf16_f32 v77, v218, v219
v_mfma_f32_16x16x32_bf16 v[160:163], a[228:231], a[16:19], v[160:163]
ds_read_b64_tr_b16 a[62:63], v21 offset:4608
v_cvt_pk_bf16_f32 v78, v220, v221
v_mfma_f32_16x16x32_bf16 v[168:171], a[244:247], a[16:19], v[168:171]
v_cvt_pk_bf16_f32 v79, v222, v223
v_mfma_f32_16x16x32_bf16 v[132:135], a[196:199], a[20:23], v[132:135]
v_permlane16_swap_b32 v64, v66
v_mfma_f32_16x16x32_bf16 v[140:143], a[212:215], a[20:23], v[140:143]
buffer_load_dwordx4 v3, s[16:19], s49 offen offset:2048 lds
v_permlane16_swap_b32 v65, v67
v_mfma_f32_16x16x32_bf16 v[164:167], a[228:231], a[20:23], v[164:167]
v_permlane16_swap_b32 v68, v70
v_mfma_f32_16x16x32_bf16 v[172:175], a[244:247], a[20:23], v[172:175]
v_permlane16_swap_b32 v69, v71
v_mfma_f32_16x16x32_bf16 v[144:147], a[196:199], a[24:27], v[144:147]
buffer_load_dwordx4 v4, s[16:19], s49 offen offset:3072 lds
v_permlane16_swap_b32 v72, v74
v_mfma_f32_16x16x32_bf16 v[152:155], a[212:215], a[24:27], v[152:155]
v_permlane16_swap_b32 v73, v75
v_mfma_f32_16x16x32_bf16 v[176:179], a[228:231], a[24:27], v[176:179]
v_permlane16_swap_b32 v76, v78
v_mfma_f32_16x16x32_bf16 v[184:187], a[244:247], a[24:27], v[184:187]
v_permlane16_swap_b32 v77, v79
v_mfma_f32_16x16x32_bf16 v[148:151], a[196:199], a[28:31], v[148:151]
s_cmp_lg_u32 s89, 7
s_cbranch_scc1 L_pf16
buffer_load_dword v23, v25, s[16:19], s85 offen
L_pf16:
v_mfma_f32_16x16x32_bf16 v[156:159], a[212:215], a[28:31], v[156:159]
v_mfma_f32_16x16x32_bf16 v[180:183], a[228:231], a[28:31], v[180:183]
v_mfma_f32_16x16x32_bf16 v[188:191], a[244:247], a[28:31], v[188:191]
s_waitcnt lgkmcnt(0)
buffer_load_dword v6, v7, s[36:39], s58 offen sc1
s_waitcnt vmcnt(9)
v_mfma_f32_16x16x32_bf16 v[128:131], a[200:203], a[32:35], v[128:131]
s_add_u32 m0, s48, 0x0
s_or_b32 s49, s56, 8
s_lshl_b32 s49, s49, 17
s_add_u32 s56, s56, 1
s_and_b32 s56, s56, 7
buffer_load_dwordx4 v30, s[16:19], s49 offen offset:0 lds
ds_read_b64_tr_b16 a[0:1], v14 offset:32768
v_cvt_pk_bf16_f32 v80, v224, v225
v_mfma_f32_16x16x32_bf16 v[136:139], a[216:219], a[32:35], v[136:139]
ds_read_b64_tr_b16 a[2:3], v14 offset:33280
v_cvt_pk_bf16_f32 v81, v226, v227
v_mfma_f32_16x16x32_bf16 v[160:163], a[232:235], a[32:35], v[160:163]
ds_read_b64_tr_b16 a[4:5], v20 offset:32768
v_cvt_pk_bf16_f32 v82, v228, v229
v_mfma_f32_16x16x32_bf16 v[168:171], a[248:251], a[32:35], v[168:171]
ds_read_b64_tr_b16 a[6:7], v20 offset:33280
v_cvt_pk_bf16_f32 v83, v230, v231
v_mfma_f32_16x16x32_bf16 v[132:135], a[200:203], a[36:39], v[132:135]
buffer_load_dwordx4 v2, s[16:19], s49 offen offset:1024 lds
v_cvt_pk_bf16_f32 v84, v232, v233
v_mfma_f32_16x16x32_bf16 v[140:143], a[216:219], a[36:39], v[140:143]
ds_read_b64_tr_b16 a[8:9], v15 offset:32768
v_cvt_pk_bf16_f32 v85, v234, v235
v_mfma_f32_16x16x32_bf16 v[164:167], a[232:235], a[36:39], v[164:167]
ds_read_b64_tr_b16 a[10:11], v15 offset:33280
v_mfma_f32_16x16x32_bf16 v[172:175], a[248:251], a[36:39], v[172:175]
ds_read_b64_tr_b16 a[12:13], v21 offset:32768
v_cvt_pk_bf16_f32 v86, v236, v237
v_mfma_f32_16x16x32_bf16 v[144:147], a[200:203], a[40:43], v[144:147]
buffer_load_dwordx4 v3, s[16:19], s49 offen offset:2048 lds
ds_read_b64_tr_b16 a[14:15], v21 offset:33280
v_cvt_pk_bf16_f32 v87, v238, v239
v_mfma_f32_16x16x32_bf16 v[152:155], a[216:219], a[40:43], v[152:155]
v_cvt_pk_bf16_f32 v88, v240, v241
v_mfma_f32_16x16x32_bf16 v[176:179], a[232:235], a[40:43], v[176:179]
ds_read_b64_tr_b16 a[16:17], v14 offset:36864
v_cvt_pk_bf16_f32 v89, v242, v243
v_mfma_f32_16x16x32_bf16 v[184:187], a[248:251], a[40:43], v[184:187]
ds_read_b64_tr_b16 a[18:19], v14 offset:37376
v_cvt_pk_bf16_f32 v90, v244, v245
v_mfma_f32_16x16x32_bf16 v[148:151], a[200:203], a[44:47], v[148:151]
buffer_load_dwordx4 v4, s[16:19], s49 offen offset:3072 lds
ds_read_b64_tr_b16 a[20:21], v20 offset:36864
v_cvt_pk_bf16_f32 v91, v246, v247
v_mfma_f32_16x16x32_bf16 v[156:159], a[216:219], a[44:47], v[156:159]
ds_read_b64_tr_b16 a[22:23], v20 offset:37376
v_mfma_f32_16x16x32_bf16 v[180:183], a[232:235], a[44:47], v[180:183]
v_cvt_pk_bf16_f32 v92, v248, v249
v_mfma_f32_16x16x32_bf16 v[188:191], a[248:251], a[44:47], v[188:191]
ds_read_b64_tr_b16 a[24:25], v15 offset:36864
v_cvt_pk_bf16_f32 v93, v250, v251
v_mfma_f32_16x16x32_bf16 v[128:131], a[204:207], a[48:51], v[128:131]
s_add_u32 m0, s48, 0x1000
s_add_u32 s49, s49, 0x10000
buffer_load_dwordx4 v30, s[16:19], s49 offen offset:0 lds
ds_read_b64_tr_b16 a[26:27], v15 offset:37376
v_cvt_pk_bf16_f32 v94, v252, v253
v_mfma_f32_16x16x32_bf16 v[136:139], a[220:223], a[48:51], v[136:139]
ds_read_b64_tr_b16 a[28:29], v21 offset:36864
v_cvt_pk_bf16_f32 v95, v254, v255
v_mfma_f32_16x16x32_bf16 v[160:163], a[236:239], a[48:51], v[160:163]
ds_read_b64_tr_b16 a[30:31], v21 offset:37376
v_permlane16_swap_b32 v80, v82
v_mfma_f32_16x16x32_bf16 v[168:171], a[252:255], a[48:51], v[168:171]
v_permlane16_swap_b32 v81, v83
v_mfma_f32_16x16x32_bf16 v[132:135], a[204:207], a[52:55], v[132:135]
buffer_load_dwordx4 v2, s[16:19], s49 offen offset:1024 lds
v_mfma_f32_16x16x32_bf16 v[140:143], a[220:223], a[52:55], v[140:143]
v_permlane16_swap_b32 v84, v86
v_mfma_f32_16x16x32_bf16 v[164:167], a[236:239], a[52:55], v[164:167]
v_permlane16_swap_b32 v85, v87
v_mfma_f32_16x16x32_bf16 v[172:175], a[252:255], a[52:55], v[172:175]
v_permlane16_swap_b32 v88, v90
v_mfma_f32_16x16x32_bf16 v[144:147], a[204:207], a[56:59], v[144:147]
buffer_load_dwordx4 v3, s[16:19], s49 offen offset:2048 lds
v_permlane16_swap_b32 v89, v91
v_mfma_f32_16x16x32_bf16 v[152:155], a[220:223], a[56:59], v[152:155]
v_permlane16_swap_b32 v92, v94
v_mfma_f32_16x16x32_bf16 v[176:179], a[236:239], a[56:59], v[176:179]
v_permlane16_swap_b32 v93, v95
v_mfma_f32_16x16x32_bf16 v[184:187], a[252:255], a[56:59], v[184:187]
v_mfma_f32_16x16x32_bf16 v[148:151], a[204:207], a[60:63], v[148:151]
buffer_load_dwordx4 v4, s[16:19], s49 offen offset:3072 lds
v_mfma_f32_16x16x32_bf16 v[156:159], a[220:223], a[60:63], v[156:159]
v_mfma_f32_16x16x32_bf16 v[180:183], a[236:239], a[60:63], v[180:183]
v_mfma_f32_16x16x32_bf16 v[188:191], a[252:255], a[60:63], v[188:191]
s_waitcnt lgkmcnt(0)
s_waitcnt vmcnt(8)
s_mov_b32 s45, 0
L_poll:
v_cmp_ne_u32 vcc, v5, v6
s_nop 4
s_cbranch_vccz L_polled
s_add_u32 s45, s45, 1
s_cmp_ge_u32 s45, 0x200000
s_cbranch_scc1 L_polled
buffer_load_dword v6, v7, s[36:39], s58 offen sc1
s_waitcnt vmcnt(0)
s_branch L_poll
L_polled:
s_waitcnt vmcnt(9)
v_mfma_f32_16x16x32_bf16 v[192:195], a[192:195], a[0:3], 0
s_or_b32 s50, s55, 0
s_lshl_b32 s50, s50, 11
s_add_u32 s50, s50, s59
s_xor_b32 s51, s50, 0x10000
s_add_u32 s55, s55, 1
s_and_b32 s55, s55, 3
buffer_load_dwordx4 a[64:67], v31, s[36:39], s50 offen offset:0 sc1
ds_read_b64_tr_b16 a[32:33], v16 offset:0
v_mfma_f32_16x16x32_bf16 v[200:203], a[208:211], a[0:3], 0
buffer_load_dwordx4 a[68:71], v31, s[36:39], s50 offen offset:1024 sc1
ds_read_b64_tr_b16 a[34:35], v16 offset:512
v_mfma_f32_16x16x32_bf16 v[224:227], a[224:227], a[0:3], 0
ds_read_b64_tr_b16 a[36:37], v12 offset:0
v_mfma_f32_16x16x32_bf16 v[232:235], a[240:243], a[0:3], 0
buffer_load_dwordx4 a[72:75], v31, s[36:39], s51 offen offset:0 sc1
ds_read_b64_tr_b16 a[38:39], v12 offset:512
v_mfma_f32_16x16x32_bf16 v[196:199], a[192:195], a[4:7], 0
buffer_load_dwordx4 a[76:79], v31, s[36:39], s51 offen offset:1024 sc1
v_cvt_pk_bf16_f32 v96, v128, v129
v_mfma_f32_16x16x32_bf16 v[204:207], a[208:211], a[4:7], 0
ds_read_b64_tr_b16 a[40:41], v17 offset:0
v_cvt_pk_bf16_f32 v97, v130, v131
v_mfma_f32_16x16x32_bf16 v[228:231], a[224:227], a[4:7], 0
s_or_b32 s50, s55, 0
s_lshl_b32 s50, s50, 11
s_add_u32 s50, s50, s59
s_xor_b32 s51, s50, 0x10000
s_add_u32 s55, s55, 1
s_and_b32 s55, s55, 3
buffer_load_dwordx4 a[80:83], v31, s[36:39], s50 offen offset:0 sc1
ds_read_b64_tr_b16 a[42:43], v17 offset:512
v_cvt_pk_bf16_f32 v98, v132, v133
v_mfma_f32_16x16x32_bf16 v[236:239], a[240:243], a[4:7], 0
ds_read_b64_tr_b16 a[44:45], v13 offset:0
v_cvt_pk_bf16_f32 v99, v134, v135
v_mfma_f32_16x16x32_bf16 v[208:211], a[192:195], a[8:11], 0
buffer_load_dwordx4 a[84:87], v31, s[36:39], s50 offen offset:1024 sc1
ds_read_b64_tr_b16 a[46:47], v13 offset:512
v_cvt_pk_bf16_f32 v100, v136, v137
v_mfma_f32_16x16x32_bf16 v[216:219], a[208:211], a[8:11], 0
buffer_load_dwordx4 a[88:91], v31, s[36:39], s51 offen offset:0 sc1
v_cvt_pk_bf16_f32 v101, v138, v139
v_mfma_f32_16x16x32_bf16 v[240:243], a[224:227], a[8:11], 0
ds_read_b64_tr_b16 a[48:49], v16 offset:4096
v_cvt_pk_bf16_f32 v102, v140, v141
v_mfma_f32_16x16x32_bf16 v[248:251], a[240:243], a[8:11], 0
buffer_load_dwordx4 a[92:95], v31, s[36:39], s51 offen offset:1024 sc1
ds_read_b64_tr_b16 a[50:51], v16 offset:4608
v_cvt_pk_bf16_f32 v103, v142, v143
v_mfma_f32_16x16x32_bf16 v[212:215], a[192:195], a[12:15], 0
s_or_b32 s50, s55, 0
s_lshl_b32 s50, s50, 11
s_add_u32 s50, s50, s59
s_xor_b32 s51, s50, 0x10000
s_add_u32 s55, s55, 1
s_and_b32 s55, s55, 3
buffer_load_dwordx4 a[96:99], v31, s[36:39], s50 offen offset:0 sc1
ds_read_b64_tr_b16 a[52:53], v12 offset:4096
v_cvt_pk_bf16_f32 v104, v144, v145
v_mfma_f32_16x16x32_bf16 v[220:223], a[208:211], a[12:15], 0
ds_read_b64_tr_b16 a[54:55], v12 offset:4608
v_cvt_pk_bf16_f32 v105, v146, v147
v_mfma_f32_16x16x32_bf16 v[244:247], a[224:227], a[12:15], 0
buffer_load_dwordx4 a[100:103], v31, s[36:39], s50 offen offset:1024 sc1
v_cvt_pk_bf16_f32 v106, v148, v149
v_mfma_f32_16x16x32_bf16 v[252:255], a[240:243], a[12:15], 0
ds_read_b64_tr_b16 a[56:57], v17 offset:4096
v_cvt_pk_bf16_f32 v107, v150, v151
v_mfma_f32_16x16x32_bf16 v[192:195], a[196:199], a[16:19], v[192:195]
buffer_load_dwordx4 a[104:107], v31, s[36:39], s51 offen offset:0 sc1
ds_read_b64_tr_b16 a[58:59], v17 offset:4608
v_cvt_pk_bf16_f32 v108, v152, v153
v_mfma_f32_16x16x32_bf16 v[200:203], a[212:215], a[16:19], v[200:203]
buffer_load_dwordx4 a[108:111], v31, s[36:39], s51 offen offset:1024 sc1
ds_read_b64_tr_b16 a[60:61], v13 offset:4096
v_cvt_pk_bf16_f32 v109, v154, v155
v_mfma_f32_16x16x32_bf16 v[224:227], a[228:231], a[16:19], v[224:227]
ds_read_b64_tr_b16 a[62:63], v13 offset:4608
v_cvt_pk_bf16_f32 v110, v156, v157
v_mfma_f32_16x16x32_bf16 v[232:235], a[244:247], a[16:19], v[232:235]
s_add_u32 m0, s48, 0x8000
s_or_b32 s49, s56, 8
s_lshl_b32 s49, s49, 17
s_add_u32 s56, s56, 1
s_and_b32 s56, s56, 7
buffer_load_dwordx4 v30, s[16:19], s49 offen offset:0 lds
v_cvt_pk_bf16_f32 v111, v158, v159
v_mfma_f32_16x16x32_bf16 v[196:199], a[196:199], a[20:23], v[196:199]
buffer_load_dwordx4 v2, s[16:19], s49 offen offset:1024 lds
v_permlane16_swap_b32 v96, v98
v_mfma_f32_16x16x32_bf16 v[204:207], a[212:215], a[20:23], v[204:207]
v_permlane16_swap_b32 v97, v99
v_mfma_f32_16x16x32_bf16 v[228:231], a[228:231], a[20:23], v[228:231]
buffer_load_dwordx4 v3, s[16:19], s49 offen offset:2048 lds
v_permlane16_swap_b32 v100, v102
v_mfma_f32_16x16x32_bf16 v[236:239], a[244:247], a[20:23], v[236:239]
v_permlane16_swap_b32 v101, v103
v_mfma_f32_16x16x32_bf16 v[208:211], a[196:199], a[24:27], v[208:211]
buffer_load_dwordx4 v4, s[16:19], s49 offen offset:3072 lds
v_permlane16_swap_b32 v104, v106
v_mfma_f32_16x16x32_bf16 v[216:219], a[212:215], a[24:27], v[216:219]
s_add_u32 m0, s48, 0x9000
s_add_u32 s49, s49, 0x10000
buffer_load_dwordx4 v30, s[16:19], s49 offen offset:0 lds
v_permlane16_swap_b32 v105, v107
v_mfma_f32_16x16x32_bf16 v[240:243], a[228:231], a[24:27], v[240:243]
v_permlane16_swap_b32 v108, v110
v_mfma_f32_16x16x32_bf16 v[248:251], a[244:247], a[24:27], v[248:251]
buffer_load_dwordx4 v2, s[16:19], s49 offen offset:1024 lds
v_permlane16_swap_b32 v109, v111
v_mfma_f32_16x16x32_bf16 v[212:215], a[196:199], a[28:31], v[212:215]
buffer_load_dwordx4 v3, s[16:19], s49 offen offset:2048 lds
v_mfma_f32_16x16x32_bf16 v[220:223], a[212:215], a[28:31], v[220:223]
v_mfma_f32_16x16x32_bf16 v[244:247], a[228:231], a[28:31], v[244:247]
buffer_load_dwordx4 v4, s[16:19], s49 offen offset:3072 lds
v_mfma_f32_16x16x32_bf16 v[252:255], a[244:247], a[28:31], v[252:255]
s_waitcnt lgkmcnt(0)
s_waitcnt vmcnt(20)
v_mfma_f32_16x16x32_bf16 v[192:195], a[200:203], a[32:35], v[192:195]
s_or_b32 s50, s55, 0
s_lshl_b32 s50, s50, 11
s_add_u32 s50, s50, s59
s_xor_b32 s51, s50, 0x10000
s_add_u32 s55, s55, 1
s_and_b32 s55, s55, 3
buffer_load_dwordx4 a[112:115], v31, s[36:39], s50 offen offset:0 sc1
ds_read_b64_tr_b16 a[0:1], v26 offset:0
v_cvt_pk_bf16_f32 v112, v160, v161
v_mfma_f32_16x16x32_bf16 v[200:203], a[216:219], a[32:35], v[200:203]
ds_read_b64_tr_b16 a[2:3], v26 offset:512
v_cvt_pk_bf16_f32 v113, v162, v163
v_mfma_f32_16x16x32_bf16 v[224:227], a[232:235], a[32:35], v[224:227]
ds_read_b64_tr_b16 a[4:5], v18 offset:0
v_cvt_pk_bf16_f32 v114, v164, v165
v_mfma_f32_16x16x32_bf16 v[232:235], a[248:251], a[32:35], v[232:235]
buffer_load_dwordx4 a[116:119], v31, s[36:39], s50 offen offset:1024 sc1
ds_read_b64_tr_b16 a[6:7], v18 offset:512
v_cvt_pk_bf16_f32 v115, v166, v167
v_mfma_f32_16x16x32_bf16 v[196:199], a[200:203], a[36:39], v[196:199]
v_cvt_pk_bf16_f32 v116, v168, v169
v_mfma_f32_16x16x32_bf16 v[204:207], a[216:219], a[36:39], v[204:207]
ds_read_b64_tr_b16 a[8:9], v27 offset:0
v_cvt_pk_bf16_f32 v117, v170, v171
v_mfma_f32_16x16x32_bf16 v[228:231], a[232:235], a[36:39], v[228:231]
buffer_load_dwordx4 a[120:123], v31, s[36:39], s51 offen offset:0 sc1
ds_read_b64_tr_b16 a[10:11], v27 offset:512
v_mfma_f32_16x16x32_bf16 v[236:239], a[248:251], a[36:39], v[236:239]
ds_read_b64_tr_b16 a[12:13], v19 offset:0
v_cvt_pk_bf16_f32 v118, v172, v173
v_mfma_f32_16x16x32_bf16 v[208:211], a[200:203], a[40:43], v[208:211]
ds_read_b64_tr_b16 a[14:15], v19 offset:512
v_cvt_pk_bf16_f32 v119, v174, v175
v_mfma_f32_16x16x32_bf16 v[216:219], a[216:219], a[40:43], v[216:219]
v_cvt_pk_bf16_f32 v120, v176, v177
v_mfma_f32_16x16x32_bf16 v[240:243], a[232:235], a[40:43], v[240:243]
buffer_load_dwordx4 a[124:127], v31, s[36:39], s51 offen offset:1024 sc1
ds_read_b64_tr_b16 a[16:17], v26 offset:4096
v_cvt_pk_bf16_f32 v121, v178, v179
v_mfma_f32_16x16x32_bf16 v[248:251], a[248:251], a[40:43], v[248:251]
ds_read_b64_tr_b16 a[18:19], v26 offset:4608
v_cvt_pk_bf16_f32 v122, v180, v181
v_mfma_f32_16x16x32_bf16 v[212:215], a[200:203], a[44:47], v[212:215]
ds_read_b64_tr_b16 a[20:21], v18 offset:4096
v_cvt_pk_bf16_f32 v123, v182, v183
v_mfma_f32_16x16x32_bf16 v[220:223], a[216:219], a[44:47], v[220:223]
s_add_u32 m0, s48, 0x10000
s_or_b32 s49, s56, 8
s_lshl_b32 s49, s49, 17
s_add_u32 s56, s56, 1
s_and_b32 s56, s56, 7
buffer_load_dwordx4 v30, s[16:19], s49 offen offset:0 lds
ds_read_b64_tr_b16 a[22:23], v18 offset:4608
v_mfma_f32_16x16x32_bf16 v[244:247], a[232:235], a[44:47], v[244:247]
v_cvt_pk_bf16_f32 v124, v184, v185
v_mfma_f32_16x16x32_bf16 v[252:255], a[248:251], a[44:47], v[252:255]
ds_read_b64_tr_b16 a[24:25], v27 offset:4096
v_cvt_pk_bf16_f32 v125, v186, v187
v_mfma_f32_16x16x32_bf16 v[192:195], a[204:207], a[48:51], v[192:195]
buffer_load_dwordx4 v2, s[16:19], s49 offen offset:1024 lds
ds_read_b64_tr_b16 a[26:27], v27 offset:4608
v_cvt_pk_bf16_f32 v126, v188, v189
v_mfma_f32_16x16x32_bf16 v[200:203], a[220:223], a[48:51], v[200:203]
ds_read_b64_tr_b16 a[28:29], v19 offset:4096
v_cvt_pk_bf16_f32 v127, v190, v191
v_mfma_f32_16x16x32_bf16 v[224:227], a[236:239], a[48:51], v[224:227]
ds_read_b64_tr_b16 a[30:31], v19 offset:4608
v_permlane16_swap_b32 v112, v114
v_mfma_f32_16x16x32_bf16 v[232:235], a[252:255], a[48:51], v[232:235]
v_permlane16_swap_b32 v113, v115
v_mfma_f32_16x16x32_bf16 v[196:199], a[204:207], a[52:55], v[196:199]
buffer_load_dwordx4 v3, s[16:19], s49 offen offset:2048 lds
v_mfma_f32_16x16x32_bf16 v[204:207], a[220:223], a[52:55], v[204:207]
v_permlane16_swap_b32 v116, v118
v_mfma_f32_16x16x32_bf16 v[228:231], a[236:239], a[52:55], v[228:231]
v_permlane16_swap_b32 v117, v119
v_mfma_f32_16x16x32_bf16 v[236:239], a[252:255], a[52:55], v[236:239]
buffer_load_dwordx4 v4, s[16:19], s49 offen offset:3072 lds
v_permlane16_swap_b32 v120, v122
v_mfma_f32_16x16x32_bf16 v[208:211], a[204:207], a[56:59], v[208:211]
v_permlane16_swap_b32 v121, v123
v_mfma_f32_16x16x32_bf16 v[216:219], a[220:223], a[56:59], v[216:219]
v_permlane16_swap_b32 v124, v126
v_mfma_f32_16x16x32_bf16 v[240:243], a[236:239], a[56:59], v[240:243]
s_add_u32 m0, s48, 0x11000
s_add_u32 s49, s49, 0x10000
buffer_load_dwordx4 v30, s[16:19], s49 offen offset:0 lds
v_permlane16_swap_b32 v125, v127
v_mfma_f32_16x16x32_bf16 v[248:251], a[252:255], a[56:59], v[248:251]
v_mfma_f32_16x16x32_bf16 v[212:215], a[204:207], a[60:63], v[212:215]
v_mfma_f32_16x16x32_bf16 v[220:223], a[220:223], a[60:63], v[220:223]
v_mfma_f32_16x16x32_bf16 v[244:247], a[236:239], a[60:63], v[244:247]
buffer_load_dwordx4 v2, s[16:19], s49 offen offset:1024 lds
v_mfma_f32_16x16x32_bf16 v[252:255], a[252:255], a[60:63], v[252:255]
s_waitcnt vmcnt(26)
v_mfma_f32_32x32x16_bf16 a[128:143], v[32:35], a[64:67], 0
v_mfma_f32_32x32x16_bf16 a[144:159], v[40:43], a[64:67], 0
buffer_load_dwordx4 v3, s[16:19], s49 offen offset:2048 lds
v_mfma_f32_32x32x16_bf16 a[160:175], v[48:51], a[72:75], 0
v_mfma_f32_32x32x16_bf16 a[176:191], v[56:59], a[72:75], 0
v_mfma_f32_32x32x16_bf16 a[128:143], v[36:39], a[68:71], a[128:143]
buffer_load_dwordx4 v4, s[16:19], s49 offen offset:3072 lds
v_mfma_f32_32x32x16_bf16 a[144:159], v[44:47], a[68:71], a[144:159]
v_mfma_f32_32x32x16_bf16 a[160:175], v[52:55], a[76:79], a[160:175]
v_mfma_f32_32x32x16_bf16 a[176:191], v[60:63], a[76:79], a[176:191]
s_waitcnt lgkmcnt(0)
s_waitcnt vmcnt(12)
v_mfma_f32_16x16x32_bf16 v[128:131], a[192:195], a[0:3], 0
s_or_b32 s50, s55, 4
s_lshl_b32 s50, s50, 11
s_add_u32 s50, s50, s59
s_xor_b32 s51, s50, 0x10000
s_add_u32 s55, s55, 1
s_and_b32 s55, s55, 3
buffer_load_dwordx4 a[64:67], v31, s[36:39], s50 offen offset:0 sc1
ds_read_b64_tr_b16 a[32:33], v26 offset:32768
v_mfma_f32_16x16x32_bf16 v[136:139], a[208:211], a[0:3], 0
ds_read_b64_tr_b16 a[34:35], v26 offset:33280
v_mfma_f32_16x16x32_bf16 v[160:163], a[224:227], a[0:3], 0
ds_read_b64_tr_b16 a[36:37], v18 offset:32768
v_mfma_f32_16x16x32_bf16 v[168:171], a[240:243], a[0:3], 0
buffer_load_dwordx4 a[68:71], v31, s[36:39], s50 offen offset:1024 sc1
ds_read_b64_tr_b16 a[38:39], v18 offset:33280
v_mfma_f32_16x16x32_bf16 v[132:135], a[192:195], a[4:7], 0
v_cvt_pk_bf16_f32 v32, v192, v193
v_mfma_f32_16x16x32_bf16 v[140:143], a[208:211], a[4:7], 0
ds_read_b64_tr_b16 a[40:41], v27 offset:32768
v_cvt_pk_bf16_f32 v33, v194, v195
v_mfma_f32_16x16x32_bf16 v[164:167], a[224:227], a[4:7], 0
buffer_load_dwordx4 a[72:75], v31, s[36:39], s51 offen offset:0 sc1
ds_read_b64_tr_b16 a[42:43], v27 offset:33280
v_cvt_pk_bf16_f32 v34, v196, v197
v_mfma_f32_16x16x32_bf16 v[172:175], a[240:243], a[4:7], 0
ds_read_b64_tr_b16 a[44:45], v19 offset:32768
v_cvt_pk_bf16_f32 v35, v198, v199
v_mfma_f32_16x16x32_bf16 v[144:147], a[192:195], a[8:11], 0
ds_read_b64_tr_b16 a[46:47], v19 offset:33280
v_cvt_pk_bf16_f32 v36, v200, v201
v_mfma_f32_16x16x32_bf16 v[152:155], a[208:211], a[8:11], 0
v_cvt_pk_bf16_f32 v37, v202, v203
v_mfma_f32_16x16x32_bf16 v[176:179], a[224:227], a[8:11], 0
buffer_load_dwordx4 a[76:79], v31, s[36:39], s51 offen offset:1024 sc1
ds_read_b64_tr_b16 a[48:49], v26 offset:36864
v_cvt_pk_bf16_f32 v38, v204, v205
v_mfma_f32_16x16x32_bf16 v[184:187], a[240:243], a[8:11], 0
ds_read_b64_tr_b16 a[50:51], v26 offset:37376
v_cvt_pk_bf16_f32 v39, v206, v207
v_mfma_f32_16x16x32_bf16 v[148:151], a[192:195], a[12:15], 0
ds_read_b64_tr_b16 a[52:53], v18 offset:36864
v_cvt_pk_bf16_f32 v40, v208, v209
v_mfma_f32_16x16x32_bf16 v[156:159], a[208:211], a[12:15], 0
s_add_u32 m0, s48, 0x18000
s_or_b32 s49, s56, 8
s_lshl_b32 s49, s49, 17
s_add_u32 s56, s56, 1
s_and_b32 s56, s56, 7
buffer_load_dwordx4 v30, s[16:19], s49 offen offset:0 lds
ds_read_b64_tr_b16 a[54:55], v18 offset:37376
v_cvt_pk_bf16_f32 v41, v210, v211
v_mfma_f32_16x16x32_bf16 v[180:183], a[224:227], a[12:15], 0
v_cvt_pk_bf16_f32 v42, v212, v213
v_mfma_f32_16x16x32_bf16 v[188:191], a[240:243], a[12:15], 0
ds_read_b64_tr_b16 a[56:57], v27 offset:36864
v_cvt_pk_bf16_f32 v43, v214, v215
v_mfma_f32_16x16x32_bf16 v[128:131], a[196:199], a[16:19], v[128:131]
buffer_load_dwordx4 v2, s[16:19], s49 offen offset:1024 lds
ds_read_b64_tr_b16 a[58:59], v27 offset:37376
v_cvt_pk_bf16_f32 v44, v216, v217
v_mfma_f32_16x16x32_bf16 v[136:139], a[212:215], a[16:19], v[136:139]
ds_read_b64_tr_b16 a[60:61], v19 offset:36864
v_cvt_pk_bf16_f32 v45, v218, v219
v_mfma_f32_16x16x32_bf16 v[160:163], a[228:231], a[16:19], v[160:163]
ds_read_b64_tr_b16 a[62:63], v19 offset:37376
v_cvt_pk_bf16_f32 v46, v220, v221
v_mfma_f32_16x16x32_bf16 v[168:171], a[244:247], a[16:19], v[168:171]
v_cvt_pk_bf16_f32 v47, v222, v223
v_mfma_f32_16x16x32_bf16 v[132:135], a[196:199], a[20:23], v[132:135]
buffer_load_dwordx4 v3, s[16:19], s49 offen offset:2048 lds
v_permlane16_swap_b32 v32, v34
v_mfma_f32_16x16x32_bf16 v[140:143], a[212:215], a[20:23], v[140:143]
v_permlane16_swap_b32 v33, v35
v_mfma_f32_16x16x32_bf16 v[164:167], a[228:231], a[20:23], v[164:167]
v_permlane16_swap_b32 v36, v38
v_mfma_f32_16x16x32_bf16 v[172:175], a[244:247], a[20:23], v[172:175]
buffer_load_dwordx4 v4, s[16:19], s49 offen offset:3072 lds
v_permlane16_swap_b32 v37, v39
v_mfma_f32_16x16x32_bf16 v[144:147], a[196:199], a[24:27], v[144:147]
v_permlane16_swap_b32 v40, v42
v_mfma_f32_16x16x32_bf16 v[152:155], a[212:215], a[24:27], v[152:155]
v_permlane16_swap_b32 v41, v43
v_mfma_f32_16x16x32_bf16 v[176:179], a[228:231], a[24:27], v[176:179]
s_add_u32 m0, s48, 0x19000
s_add_u32 s49, s49, 0x10000
buffer_load_dwordx4 v30, s[16:19], s49 offen offset:0 lds
v_permlane16_swap_b32 v44, v46
v_mfma_f32_16x16x32_bf16 v[184:187], a[244:247], a[24:27], v[184:187]
v_permlane16_swap_b32 v45, v47
v_mfma_f32_16x16x32_bf16 v[148:151], a[196:199], a[28:31], v[148:151]
v_mfma_f32_16x16x32_bf16 v[156:159], a[212:215], a[28:31], v[156:159]
v_mfma_f32_16x16x32_bf16 v[180:183], a[228:231], a[28:31], v[180:183]
buffer_load_dwordx4 v2, s[16:19], s49 offen offset:1024 lds
v_mfma_f32_16x16x32_bf16 v[188:191], a[244:247], a[28:31], v[188:191]
s_waitcnt vmcnt(34)
v_mfma_f32_32x32x16_bf16 a[128:143], v[64:67], a[80:83], a[128:143]
v_mfma_f32_32x32x16_bf16 a[144:159], v[72:75], a[80:83], a[144:159]
buffer_load_dwordx4 v3, s[16:19], s49 offen offset:2048 lds
v_mfma_f32_32x32x16_bf16 a[160:175], v[80:83], a[88:91], a[160:175]
v_mfma_f32_32x32x16_bf16 a[176:191], v[88:91], a[88:91], a[176:191]
v_mfma_f32_32x32x16_bf16 a[128:143], v[68:71], a[84:87], a[128:143]
buffer_load_dwordx4 v4, s[16:19], s49 offen offset:3072 lds
v_mfma_f32_32x32x16_bf16 a[144:159], v[76:79], a[84:87], a[144:159]
v_mfma_f32_32x32x16_bf16 a[160:175], v[84:87], a[92:95], a[160:175]
v_mfma_f32_32x32x16_bf16 a[176:191], v[92:95], a[92:95], a[176:191]
s_waitcnt lgkmcnt(0)
s_waitcnt vmcnt(12)
v_mfma_f32_16x16x32_bf16 v[128:131], a[200:203], a[32:35], v[128:131]
s_or_b32 s50, s55, 4
s_lshl_b32 s50, s50, 11
s_add_u32 s50, s50, s59
s_xor_b32 s51, s50, 0x10000
s_add_u32 s55, s55, 1
s_and_b32 s55, s55, 3
buffer_load_dwordx4 a[80:83], v31, s[36:39], s50 offen offset:0 sc1
ds_read_b64_tr_b16 a[0:1], v14 offset:0
v_cvt_pk_bf16_f32 v48, v224, v225
v_mfma_f32_16x16x32_bf16 v[136:139], a[216:219], a[32:35], v[136:139]
ds_read_b64_tr_b16 a[2:3], v14 offset:512
v_cvt_pk_bf16_f32 v49, v226, v227
v_mfma_f32_16x16x32_bf16 v[160:163], a[232:235], a[32:35], v[160:163]
ds_read_b64_tr_b16 a[4:5], v20 offset:0
v_cvt_pk_bf16_f32 v50, v228, v229
v_mfma_f32_16x16x32_bf16 v[168:171], a[248:251], a[32:35], v[168:171]
buffer_load_dwordx4 a[84:87], v31, s[36:39], s50 offen offset:1024 sc1
ds_read_b64_tr_b16 a[6:7], v20 offset:512
v_cvt_pk_bf16_f32 v51, v230, v231
v_mfma_f32_16x16x32_bf16 v[132:135], a[200:203], a[36:39], v[132:135]
v_cvt_pk_bf16_f32 v52, v232, v233
v_mfma_f32_16x16x32_bf16 v[140:143], a[216:219], a[36:39], v[140:143]
ds_read_b64_tr_b16 a[8:9], v15 offset:0
v_cvt_pk_bf16_f32 v53, v234, v235
v_mfma_f32_16x16x32_bf16 v[164:167], a[232:235], a[36:39], v[164:167]
buffer_load_dwordx4 a[88:91], v31, s[36:39], s51 offen offset:0 sc1
ds_read_b64_tr_b16 a[10:11], v15 offset:512
v_mfma_f32_16x16x32_bf16 v[172:175], a[248:251], a[36:39], v[172:175]
ds_read_b64_tr_b16 a[12:13], v21 offset:0
v_cvt_pk_bf16_f32 v54, v236, v237
v_mfma_f32_16x16x32_bf16 v[144:147], a[200:203], a[40:43], v[144:147]
ds_read_b64_tr_b16 a[14:15], v21 offset:512
v_cvt_pk_bf16_f32 v55, v238, v239
v_mfma_f32_16x16x32_bf16 v[152:155], a[216:219], a[40:43], v[152:155]
v_cvt_pk_bf16_f32 v56, v240, v241
v_mfma_f32_16x16x32_bf16 v[176:179], a[232:235], a[40:43], v[176:179]
buffer_load_dwordx4 a[92:95], v31, s[36:39], s51 offen offset:1024 sc1
ds_read_b64_tr_b16 a[16:17], v14 offset:4096
v_cvt_pk_bf16_f32 v57, v242, v243
v_mfma_f32_16x16x32_bf16 v[184:187], a[248:251], a[40:43], v[184:187]
ds_read_b64_tr_b16 a[18:19], v14 offset:4608
v_cvt_pk_bf16_f32 v58, v244, v245
v_mfma_f32_16x16x32_bf16 v[148:151], a[200:203], a[44:47], v[148:151]
ds_read_b64_tr_b16 a[20:21], v20 offset:4096
v_cvt_pk_bf16_f32 v59, v246, v247
v_mfma_f32_16x16x32_bf16 v[156:159], a[216:219], a[44:47], v[156:159]
s_add_u32 m0, s48, 0x20000
s_or_b32 s49, s56, 8
s_lshl_b32 s49, s49, 17
s_add_u32 s56, s56, 1
s_and_b32 s56, s56, 7
buffer_load_dwordx4 v30, s[16:19], s49 offen offset:0 lds
ds_read_b64_tr_b16 a[22:23], v20 offset:4608
v_mfma_f32_16x16x32_bf16 v[180:183], a[232:235], a[44:47], v[180:183]
v_cvt_pk_bf16_f32 v60, v248, v249
v_mfma_f32_16x16x32_bf16 v[188:191], a[248:251], a[44:47], v[188:191]
ds_read_b64_tr_b16 a[24:25], v15 offset:4096
v_cvt_pk_bf16_f32 v61, v250, v251
v_mfma_f32_16x16x32_bf16 v[128:131], a[204:207], a[48:51], v[128:131]
buffer_load_dwordx4 v2, s[16:19], s49 offen offset:1024 lds
ds_read_b64_tr_b16 a[26:27], v15 offset:4608
v_cvt_pk_bf16_f32 v62, v252, v253
v_mfma_f32_16x16x32_bf16 v[136:139], a[220:223], a[48:51], v[136:139]
ds_read_b64_tr_b16 a[28:29], v21 offset:4096
v_cvt_pk_bf16_f32 v63, v254, v255
v_mfma_f32_16x16x32_bf16 v[160:163], a[236:239], a[48:51], v[160:163]
ds_read_b64_tr_b16 a[30:31], v21 offset:4608
v_permlane16_swap_b32 v48, v50
v_mfma_f32_16x16x32_bf16 v[168:171], a[252:255], a[48:51], v[168:171]
v_permlane16_swap_b32 v49, v51
v_mfma_f32_16x16x32_bf16 v[132:135], a[204:207], a[52:55], v[132:135]
buffer_load_dwordx4 v3, s[16:19], s49 offen offset:2048 lds
v_mfma_f32_16x16x32_bf16 v[140:143], a[220:223], a[52:55], v[140:143]
v_permlane16_swap_b32 v52, v54
v_mfma_f32_16x16x32_bf16 v[164:167], a[236:239], a[52:55], v[164:167]
v_permlane16_swap_b32 v53, v55
v_mfma_f32_16x16x32_bf16 v[172:175], a[252:255], a[52:55], v[172:175]
buffer_load_dwordx4 v4, s[16:19], s49 offen offset:3072 lds
v_permlane16_swap_b32 v56, v58
v_mfma_f32_16x16x32_bf16 v[144:147], a[204:207], a[56:59], v[144:147]
v_permlane16_swap_b32 v57, v59
v_mfma_f32_16x16x32_bf16 v[152:155], a[220:223], a[56:59], v[152:155]
v_permlane16_swap_b32 v60, v62
v_mfma_f32_16x16x32_bf16 v[176:179], a[236:239], a[56:59], v[176:179]
s_add_u32 m0, s48, 0x21000
s_add_u32 s49, s49, 0x10000
buffer_load_dwordx4 v30, s[16:19], s49 offen offset:0 lds
v_permlane16_swap_b32 v61, v63
v_mfma_f32_16x16x32_bf16 v[184:187], a[252:255], a[56:59], v[184:187]
v_mfma_f32_16x16x32_bf16 v[148:151], a[204:207], a[60:63], v[148:151]
v_mfma_f32_16x16x32_bf16 v[156:159], a[220:223], a[60:63], v[156:159]
v_mfma_f32_16x16x32_bf16 v[180:183], a[236:239], a[60:63], v[180:183]
buffer_load_dwordx4 v2, s[16:19], s49 offen offset:1024 lds
v_mfma_f32_16x16x32_bf16 v[188:191], a[252:255], a[60:63], v[188:191]
s_waitcnt vmcnt(42)
v_mfma_f32_32x32x16_bf16 a[128:143], v[96:99], a[96:99], a[128:143]
v_mfma_f32_32x32x16_bf16 a[144:159], v[104:107], a[96:99], a[144:159]
buffer_load_dwordx4 v3, s[16:19], s49 offen offset:2048 lds
v_mfma_f32_32x32x16_bf16 a[160:175], v[112:115], a[104:107], a[160:175]
v_mfma_f32_32x32x16_bf16 a[176:191], v[120:123], a[104:107], a[176:191]
v_mfma_f32_32x32x16_bf16 a[128:143], v[100:103], a[100:103], a[128:143]
buffer_load_dwordx4 v4, s[16:19], s49 offen offset:3072 lds
v_mfma_f32_32x32x16_bf16 a[144:159], v[108:111], a[100:103], a[144:159]
v_mfma_f32_32x32x16_bf16 a[160:175], v[116:119], a[108:111], a[160:175]
v_mfma_f32_32x32x16_bf16 a[176:191], v[124:127], a[108:111], a[176:191]
s_waitcnt lgkmcnt(0)
s_waitcnt vmcnt(12)
v_mfma_f32_16x16x32_bf16 v[192:195], a[192:195], a[0:3], 0
s_or_b32 s50, s55, 4
s_lshl_b32 s50, s50, 11
s_add_u32 s50, s50, s59
s_xor_b32 s51, s50, 0x10000
s_add_u32 s55, s55, 1
s_and_b32 s55, s55, 3
buffer_load_dwordx4 a[96:99], v31, s[36:39], s50 offen offset:0 sc1
ds_read_b64_tr_b16 a[32:33], v14 offset:32768
v_mfma_f32_16x16x32_bf16 v[200:203], a[208:211], a[0:3], 0
ds_read_b64_tr_b16 a[34:35], v14 offset:33280
v_mfma_f32_16x16x32_bf16 v[224:227], a[224:227], a[0:3], 0
ds_read_b64_tr_b16 a[36:37], v20 offset:32768
v_mfma_f32_16x16x32_bf16 v[232:235], a[240:243], a[0:3], 0
buffer_load_dwordx4 a[100:103], v31, s[36:39], s50 offen offset:1024 sc1
ds_read_b64_tr_b16 a[38:39], v20 offset:33280
v_mfma_f32_16x16x32_bf16 v[196:199], a[192:195], a[4:7], 0
v_cvt_pk_bf16_f32 v64, v128, v129
v_mfma_f32_16x16x32_bf16 v[204:207], a[208:211], a[4:7], 0
ds_read_b64_tr_b16 a[40:41], v15 offset:32768
v_cvt_pk_bf16_f32 v65, v130, v131
v_mfma_f32_16x16x32_bf16 v[228:231], a[224:227], a[4:7], 0
buffer_load_dwordx4 a[104:107], v31, s[36:39], s51 offen offset:0 sc1
ds_read_b64_tr_b16 a[42:43], v15 offset:33280
v_cvt_pk_bf16_f32 v66, v132, v133
v_mfma_f32_16x16x32_bf16 v[236:239], a[240:243], a[4:7], 0
ds_read_b64_tr_b16 a[44:45], v21 offset:32768
v_cvt_pk_bf16_f32 v67, v134, v135
v_mfma_f32_16x16x32_bf16 v[208:211], a[192:195], a[8:11], 0
ds_read_b64_tr_b16 a[46:47], v21 offset:33280
v_cvt_pk_bf16_f32 v68, v136, v137
v_mfma_f32_16x16x32_bf16 v[216:219], a[208:211], a[8:11], 0
v_cvt_pk_bf16_f32 v69, v138, v139
v_mfma_f32_16x16x32_bf16 v[240:243], a[224:227], a[8:11], 0
buffer_load_dwordx4 a[108:111], v31, s[36:39], s51 offen offset:1024 sc1
ds_read_b64_tr_b16 a[48:49], v14 offset:36864
v_cvt_pk_bf16_f32 v70, v140, v141
v_mfma_f32_16x16x32_bf16 v[248:251], a[240:243], a[8:11], 0
ds_read_b64_tr_b16 a[50:51], v14 offset:37376
v_cvt_pk_bf16_f32 v71, v142, v143
v_mfma_f32_16x16x32_bf16 v[212:215], a[192:195], a[12:15], 0
ds_read_b64_tr_b16 a[52:53], v20 offset:36864
v_cvt_pk_bf16_f32 v72, v144, v145
v_mfma_f32_16x16x32_bf16 v[220:223], a[208:211], a[12:15], 0
s_add_u32 m0, s48, 0x0
s_or_b32 s49, s56, 8
s_lshl_b32 s49, s49, 17
s_add_u32 s56, s56, 1
s_and_b32 s56, s56, 7
buffer_load_dwordx4 v30, s[16:19], s49 offen offset:0 lds
ds_read_b64_tr_b16 a[54:55], v20 offset:37376
v_cvt_pk_bf16_f32 v73, v146, v147
v_mfma_f32_16x16x32_bf16 v[244:247], a[224:227], a[12:15], 0
v_cvt_pk_bf16_f32 v74, v148, v149
v_mfma_f32_16x16x32_bf16 v[252:255], a[240:243], a[12:15], 0
ds_read_b64_tr_b16 a[56:57], v15 offset:36864
v_cvt_pk_bf16_f32 v75, v150, v151
v_mfma_f32_16x16x32_bf16 v[192:195], a[196:199], a[16:19], v[192:195]
buffer_load_dwordx4 v2, s[16:19], s49 offen offset:1024 lds
ds_read_b64_tr_b16 a[58:59], v15 offset:37376
v_cvt_pk_bf16_f32 v76, v152, v153
v_mfma_f32_16x16x32_bf16 v[200:203], a[212:215], a[16:19], v[200:203]
ds_read_b64_tr_b16 a[60:61], v21 offset:36864
v_cvt_pk_bf16_f32 v77, v154, v155
v_mfma_f32_16x16x32_bf16 v[224:227], a[228:231], a[16:19], v[224:227]
ds_read_b64_tr_b16 a[62:63], v21 offset:37376
v_cvt_pk_bf16_f32 v78, v156, v157
v_mfma_f32_16x16x32_bf16 v[232:235], a[244:247], a[16:19], v[232:235]
v_cvt_pk_bf16_f32 v79, v158, v159
v_mfma_f32_16x16x32_bf16 v[196:199], a[196:199], a[20:23], v[196:199]
buffer_load_dwordx4 v3, s[16:19], s49 offen offset:2048 lds
v_permlane16_swap_b32 v64, v66
v_mfma_f32_16x16x32_bf16 v[204:207], a[212:215], a[20:23], v[204:207]
v_permlane16_swap_b32 v65, v67
v_mfma_f32_16x16x32_bf16 v[228:231], a[228:231], a[20:23], v[228:231]
v_permlane16_swap_b32 v68, v70
v_mfma_f32_16x16x32_bf16 v[236:239], a[244:247], a[20:23], v[236:239]
buffer_load_dwordx4 v4, s[16:19], s49 offen offset:3072 lds
v_permlane16_swap_b32 v69, v71
v_mfma_f32_16x16x32_bf16 v[208:211], a[196:199], a[24:27], v[208:211]
v_permlane16_swap_b32 v72, v74
v_mfma_f32_16x16x32_bf16 v[216:219], a[212:215], a[24:27], v[216:219]
v_permlane16_swap_b32 v73, v75
v_mfma_f32_16x16x32_bf16 v[240:243], a[228:231], a[24:27], v[240:243]
s_add_u32 m0, s48, 0x1000
s_add_u32 s49, s49, 0x10000
buffer_load_dwordx4 v30, s[16:19], s49 offen offset:0 lds
v_permlane16_swap_b32 v76, v78
v_mfma_f32_16x16x32_bf16 v[248:251], a[244:247], a[24:27], v[248:251]
v_permlane16_swap_b32 v77, v79
v_mfma_f32_16x16x32_bf16 v[212:215], a[196:199], a[28:31], v[212:215]
v_mfma_f32_16x16x32_bf16 v[220:223], a[212:215], a[28:31], v[220:223]
v_mfma_f32_16x16x32_bf16 v[244:247], a[228:231], a[28:31], v[244:247]
buffer_load_dwordx4 v2, s[16:19], s49 offen offset:1024 lds
v_mfma_f32_16x16x32_bf16 v[252:255], a[244:247], a[28:31], v[252:255]
s_waitcnt vmcnt(42)
v_mfma_f32_32x32x16_bf16 a[128:143], v[32:35], a[112:115], a[128:143]
v_mfma_f32_32x32x16_bf16 a[144:159], v[40:43], a[112:115], a[144:159]
buffer_load_dwordx4 v3, s[16:19], s49 offen offset:2048 lds
v_mfma_f32_32x32x16_bf16 a[160:175], v[48:51], a[120:123], a[160:175]
v_mfma_f32_32x32x16_bf16 a[176:191], v[56:59], a[120:123], a[176:191]
v_mfma_f32_32x32x16_bf16 a[128:143], v[36:39], a[116:119], a[128:143]
buffer_load_dwordx4 v4, s[16:19], s49 offen offset:3072 lds
v_mfma_f32_32x32x16_bf16 a[144:159], v[44:47], a[116:119], a[144:159]
v_mfma_f32_32x32x16_bf16 a[160:175], v[52:55], a[124:127], a[160:175]
v_mfma_f32_32x32x16_bf16 a[176:191], v[60:63], a[124:127], a[176:191]
s_waitcnt lgkmcnt(0)
s_waitcnt vmcnt(12)
v_mfma_f32_16x16x32_bf16 v[192:195], a[200:203], a[32:35], v[192:195]
s_or_b32 s50, s55, 4
s_lshl_b32 s50, s50, 11
s_add_u32 s50, s50, s59
s_xor_b32 s51, s50, 0x10000
s_add_u32 s55, s55, 1
s_and_b32 s55, s55, 3
buffer_load_dwordx4 a[112:115], v31, s[36:39], s50 offen offset:0 sc1
ds_read_b64_tr_b16 a[0:1], v16 offset:0
v_cvt_pk_bf16_f32 v80, v160, v161
v_mfma_f32_16x16x32_bf16 v[200:203], a[216:219], a[32:35], v[200:203]
ds_read_b64_tr_b16 a[2:3], v16 offset:512
v_cvt_pk_bf16_f32 v81, v162, v163
v_mfma_f32_16x16x32_bf16 v[224:227], a[232:235], a[32:35], v[224:227]
ds_read_b64_tr_b16 a[4:5], v12 offset:0
v_cvt_pk_bf16_f32 v82, v164, v165
v_mfma_f32_16x16x32_bf16 v[232:235], a[248:251], a[32:35], v[232:235]
buffer_load_dwordx4 a[116:119], v31, s[36:39], s50 offen offset:1024 sc1
ds_read_b64_tr_b16 a[6:7], v12 offset:512
v_cvt_pk_bf16_f32 v83, v166, v167
v_mfma_f32_16x16x32_bf16 v[196:199], a[200:203], a[36:39], v[196:199]
v_cvt_pk_bf16_f32 v84, v168, v169
v_mfma_f32_16x16x32_bf16 v[204:207], a[216:219], a[36:39], v[204:207]
ds_read_b64_tr_b16 a[8:9], v17 offset:0
v_cvt_pk_bf16_f32 v85, v170, v171
v_mfma_f32_16x16x32_bf16 v[228:231], a[232:235], a[36:39], v[228:231]
buffer_load_dwordx4 a[120:123], v31, s[36:39], s51 offen offset:0 sc1
ds_read_b64_tr_b16 a[10:11], v17 offset:512
v_mfma_f32_16x16x32_bf16 v[236:239], a[248:251], a[36:39], v[236:239]
ds_read_b64_tr_b16 a[12:13], v13 offset:0
v_cvt_pk_bf16_f32 v86, v172, v173
v_mfma_f32_16x16x32_bf16 v[208:211], a[200:203], a[40:43], v[208:211]
ds_read_b64_tr_b16 a[14:15], v13 offset:512
v_cvt_pk_bf16_f32 v87, v174, v175
v_mfma_f32_16x16x32_bf16 v[216:219], a[216:219], a[40:43], v[216:219]
v_cvt_pk_bf16_f32 v88, v176, v177
v_mfma_f32_16x16x32_bf16 v[240:243], a[232:235], a[40:43], v[240:243]
buffer_load_dwordx4 a[124:127], v31, s[36:39], s51 offen offset:1024 sc1
ds_read_b64_tr_b16 a[16:17], v16 offset:4096
v_cvt_pk_bf16_f32 v89, v178, v179
v_mfma_f32_16x16x32_bf16 v[248:251], a[248:251], a[40:43], v[248:251]
ds_read_b64_tr_b16 a[18:19], v16 offset:4608
v_cvt_pk_bf16_f32 v90, v180, v181
v_mfma_f32_16x16x32_bf16 v[212:215], a[200:203], a[44:47], v[212:215]
ds_read_b64_tr_b16 a[20:21], v12 offset:4096
v_cvt_pk_bf16_f32 v91, v182, v183
v_mfma_f32_16x16x32_bf16 v[220:223], a[216:219], a[44:47], v[220:223]
s_add_u32 m0, s48, 0x8000
s_or_b32 s49, s56, 8
s_lshl_b32 s49, s49, 17
s_add_u32 s56, s56, 1
s_and_b32 s56, s56, 7
buffer_load_dwordx4 v30, s[16:19], s49 offen offset:0 lds
ds_read_b64_tr_b16 a[22:23], v12 offset:4608
v_mfma_f32_16x16x32_bf16 v[244:247], a[232:235], a[44:47], v[244:247]
v_cvt_pk_bf16_f32 v92, v184, v185
v_mfma_f32_16x16x32_bf16 v[252:255], a[248:251], a[44:47], v[252:255]
ds_read_b64_tr_b16 a[24:25], v17 offset:4096
v_cvt_pk_bf16_f32 v93, v186, v187
v_mfma_f32_16x16x32_bf16 v[192:195], a[204:207], a[48:51], v[192:195]
buffer_load_dwordx4 v2, s[16:19], s49 offen offset:1024 lds
ds_read_b64_tr_b16 a[26:27], v17 offset:4608
v_cvt_pk_bf16_f32 v94, v188, v189
v_mfma_f32_16x16x32_bf16 v[200:203], a[220:223], a[48:51], v[200:203]
ds_read_b64_tr_b16 a[28:29], v13 offset:4096
v_cvt_pk_bf16_f32 v95, v190, v191
v_mfma_f32_16x16x32_bf16 v[224:227], a[236:239], a[48:51], v[224:227]
ds_read_b64_tr_b16 a[30:31], v13 offset:4608
v_permlane16_swap_b32 v80, v82
v_mfma_f32_16x16x32_bf16 v[232:235], a[252:255], a[48:51], v[232:235]
v_permlane16_swap_b32 v81, v83
v_mfma_f32_16x16x32_bf16 v[196:199], a[204:207], a[52:55], v[196:199]
buffer_load_dwordx4 v3, s[16:19], s49 offen offset:2048 lds
v_mfma_f32_16x16x32_bf16 v[204:207], a[220:223], a[52:55], v[204:207]
v_permlane16_swap_b32 v84, v86
v_mfma_f32_16x16x32_bf16 v[228:231], a[236:239], a[52:55], v[228:231]
v_permlane16_swap_b32 v85, v87
v_mfma_f32_16x16x32_bf16 v[236:239], a[252:255], a[52:55], v[236:239]
buffer_load_dwordx4 v4, s[16:19], s49 offen offset:3072 lds
v_permlane16_swap_b32 v88, v90
v_mfma_f32_16x16x32_bf16 v[208:211], a[204:207], a[56:59], v[208:211]
v_permlane16_swap_b32 v89, v91
v_mfma_f32_16x16x32_bf16 v[216:219], a[220:223], a[56:59], v[216:219]
v_permlane16_swap_b32 v92, v94
v_mfma_f32_16x16x32_bf16 v[240:243], a[236:239], a[56:59], v[240:243]
s_add_u32 m0, s48, 0x9000
s_add_u32 s49, s49, 0x10000
buffer_load_dwordx4 v30, s[16:19], s49 offen offset:0 lds
v_permlane16_swap_b32 v93, v95
v_mfma_f32_16x16x32_bf16 v[248:251], a[252:255], a[56:59], v[248:251]
v_mfma_f32_16x16x32_bf16 v[212:215], a[204:207], a[60:63], v[212:215]
v_mfma_f32_16x16x32_bf16 v[220:223], a[220:223], a[60:63], v[220:223]
v_mfma_f32_16x16x32_bf16 v[244:247], a[236:239], a[60:63], v[244:247]
buffer_load_dwordx4 v2, s[16:19], s49 offen offset:1024 lds
v_mfma_f32_16x16x32_bf16 v[252:255], a[252:255], a[60:63], v[252:255]
s_waitcnt vmcnt(42)
v_mfma_f32_32x32x16_bf16 a[128:143], v[64:67], a[64:67], a[128:143]
v_mfma_f32_32x32x16_bf16 a[144:159], v[72:75], a[64:67], a[144:159]
buffer_load_dwordx4 v3, s[16:19], s49 offen offset:2048 lds
v_mfma_f32_32x32x16_bf16 a[160:175], v[80:83], a[72:75], a[160:175]
v_mfma_f32_32x32x16_bf16 a[176:191], v[88:91], a[72:75], a[176:191]
v_mfma_f32_32x32x16_bf16 a[128:143], v[68:71], a[68:71], a[128:143]
buffer_load_dwordx4 v4, s[16:19], s49 offen offset:3072 lds
v_mfma_f32_32x32x16_bf16 a[144:159], v[76:79], a[68:71], a[144:159]
v_mfma_f32_32x32x16_bf16 a[160:175], v[84:87], a[76:79], a[160:175]
v_mfma_f32_32x32x16_bf16 a[176:191], v[92:95], a[76:79], a[176:191]
s_waitcnt lgkmcnt(0)
s_waitcnt vmcnt(12)
v_mfma_f32_16x16x32_bf16 v[128:131], a[192:195], a[0:3], 0
s_add_u32 m0, s48, 0x10000
s_or_b32 s49, s56, 8
s_lshl_b32 s49, s49, 17
s_add_u32 s56, s56, 1
s_and_b32 s56, s56, 7
buffer_load_dwordx4 v30, s[16:19], s49 offen offset:0 lds
ds_read_b64_tr_b16 a[32:33], v26 offset:0
v_mfma_f32_16x16x32_bf16 v[136:139], a[208:211], a[0:3], 0
ds_read_b64_tr_b16 a[34:35], v26 offset:512
v_mfma_f32_16x16x32_bf16 v[160:163], a[224:227], a[0:3], 0
ds_read_b64_tr_b16 a[36:37], v18 offset:0
v_mfma_f32_16x16x32_bf16 v[168:171], a[240:243], a[0:3], 0
ds_read_b64_tr_b16 a[38:39], v18 offset:512
v_mfma_f32_16x16x32_bf16 v[132:135], a[192:195], a[4:7], 0
buffer_load_dwordx4 v2, s[16:19], s49 offen offset:1024 lds
v_cvt_pk_bf16_f32 v96, v192, v193
v_mfma_f32_16x16x32_bf16 v[140:143], a[208:211], a[4:7], 0
ds_read_b64_tr_b16 a[40:41], v27 offset:0
v_cvt_pk_bf16_f32 v97, v194, v195
v_mfma_f32_16x16x32_bf16 v[164:167], a[224:227], a[4:7], 0
ds_read_b64_tr_b16 a[42:43], v27 offset:512
v_cvt_pk_bf16_f32 v98, v196, v197
v_mfma_f32_16x16x32_bf16 v[172:175], a[240:243], a[4:7], 0
ds_read_b64_tr_b16 a[44:45], v19 offset:0
v_cvt_pk_bf16_f32 v99, v198, v199
v_mfma_f32_16x16x32_bf16 v[144:147], a[192:195], a[8:11], 0
buffer_load_dwordx4 v3, s[16:19], s49 offen offset:2048 lds
ds_read_b64_tr_b16 a[46:47], v19 offset:512
v_cvt_pk_bf16_f32 v100, v200, v201
v_mfma_f32_16x16x32_bf16 v[152:155], a[208:211], a[8:11], 0
v_cvt_pk_bf16_f32 v101, v202, v203
v_mfma_f32_16x16x32_bf16 v[176:179], a[224:227], a[8:11], 0
ds_read_b64_tr_b16 a[48:49], v26 offset:4096
v_cvt_pk_bf16_f32 v102, v204, v205
v_mfma_f32_16x16x32_bf16 v[184:187], a[240:243], a[8:11], 0
ds_read_b64_tr_b16 a[50:51], v26 offset:4608
v_cvt_pk_bf16_f32 v103, v206, v207
v_mfma_f32_16x16x32_bf16 v[148:151], a[192:195], a[12:15], 0
buffer_load_dwordx4 v4, s[16:19], s49 offen offset:3072 lds
ds_read_b64_tr_b16 a[52:53], v18 offset:4096
v_cvt_pk_bf16_f32 v104, v208, v209
v_mfma_f32_16x16x32_bf16 v[156:159], a[208:211], a[12:15], 0
ds_read_b64_tr_b16 a[54:55], v18 offset:4608
v_cvt_pk_bf16_f32 v105, v210, v211
v_mfma_f32_16x16x32_bf16 v[180:183], a[224:227], a[12:15], 0
v_cvt_pk_bf16_f32 v106, v212, v213
v_mfma_f32_16x16x32_bf16 v[188:191], a[240:243], a[12:15], 0
ds_read_b64_tr_b16 a[56:57], v27 offset:4096
v_cvt_pk_bf16_f32 v107, v214, v215
v_mfma_f32_16x16x32_bf16 v[128:131], a[196:199], a[16:19], v[128:131]
s_add_u32 m0, s48, 0x11000
s_add_u32 s49, s49, 0x10000
buffer_load_dwordx4 v30, s[16:19], s49 offen offset:0 lds
ds_read_b64_tr_b16 a[58:59], v27 offset:4608
v_cvt_pk_bf16_f32 v108, v216, v217
v_mfma_f32_16x16x32_bf16 v[136:139], a[212:215], a[16:19], v[136:139]
ds_read_b64_tr_b16 a[60:61], v19 offset:4096
v_cvt_pk_bf16_f32 v109, v218, v219
v_mfma_f32_16x16x32_bf16 v[160:163], a[228:231], a[16:19], v[160:163]
ds_read_b64_tr_b16 a[62:63], v19 offset:4608
v_cvt_pk_bf16_f32 v110, v220, v221
v_mfma_f32_16x16x32_bf16 v[168:171], a[244:247], a[16:19], v[168:171]
v_cvt_pk_bf16_f32 v111, v222, v223
v_mfma_f32_16x16x32_bf16 v[132:135], a[196:199], a[20:23], v[132:135]
buffer_load_dwordx4 v2, s[16:19], s49 offen offset:1024 lds
v_permlane16_swap_b32 v96, v98
v_mfma_f32_16x16x32_bf16 v[140:143], a[212:215], a[20:23], v[140:143]
v_permlane16_swap_b32 v97, v99
v_mfma_f32_16x16x32_bf16 v[164:167], a[228:231], a[20:23], v[164:167]
v_permlane16_swap_b32 v100, v102
v_mfma_f32_16x16x32_bf16 v[172:175], a[244:247], a[20:23], v[172:175]
v_permlane16_swap_b32 v101, v103
v_mfma_f32_16x16x32_bf16 v[144:147], a[196:199], a[24:27], v[144:147]
buffer_load_dwordx4 v3, s[16:19], s49 offen offset:2048 lds
v_permlane16_swap_b32 v104, v106
v_mfma_f32_16x16x32_bf16 v[152:155], a[212:215], a[24:27], v[152:155]
v_permlane16_swap_b32 v105, v107
v_mfma_f32_16x16x32_bf16 v[176:179], a[228:231], a[24:27], v[176:179]
v_permlane16_swap_b32 v108, v110
v_mfma_f32_16x16x32_bf16 v[184:187], a[244:247], a[24:27], v[184:187]
v_permlane16_swap_b32 v109, v111
v_mfma_f32_16x16x32_bf16 v[148:151], a[196:199], a[28:31], v[148:151]
buffer_load_dwordx4 v4, s[16:19], s49 offen offset:3072 lds
v_mfma_f32_16x16x32_bf16 v[156:159], a[212:215], a[28:31], v[156:159]
v_mfma_f32_16x16x32_bf16 v[180:183], a[228:231], a[28:31], v[180:183]
v_mfma_f32_16x16x32_bf16 v[188:191], a[244:247], a[28:31], v[188:191]
s_waitcnt lgkmcnt(0)
s_waitcnt vmcnt(8)
v_mfma_f32_16x16x32_bf16 v[128:131], a[200:203], a[32:35], v[128:131]
ds_read_b64_tr_b16 a[0:1], v26 offset:32768
v_cvt_pk_bf16_f32 v112, v224, v225
v_mfma_f32_16x16x32_bf16 v[136:139], a[216:219], a[32:35], v[136:139]
ds_read_b64_tr_b16 a[2:3], v26 offset:33280
v_cvt_pk_bf16_f32 v113, v226, v227
v_mfma_f32_16x16x32_bf16 v[160:163], a[232:235], a[32:35], v[160:163]
ds_read_b64_tr_b16 a[4:5], v18 offset:32768
v_cvt_pk_bf16_f32 v114, v228, v229
v_mfma_f32_16x16x32_bf16 v[168:171], a[248:251], a[32:35], v[168:171]
ds_read_b64_tr_b16 a[6:7], v18 offset:33280
v_cvt_pk_bf16_f32 v115, v230, v231
v_mfma_f32_16x16x32_bf16 v[132:135], a[200:203], a[36:39], v[132:135]
v_cvt_pk_bf16_f32 v116, v232, v233
v_mfma_f32_16x16x32_bf16 v[140:143], a[216:219], a[36:39], v[140:143]
ds_read_b64_tr_b16 a[8:9], v27 offset:32768
v_cvt_pk_bf16_f32 v117, v234, v235
v_mfma_f32_16x16x32_bf16 v[164:167], a[232:235], a[36:39], v[164:167]
ds_read_b64_tr_b16 a[10:11], v27 offset:33280
v_mfma_f32_16x16x32_bf16 v[172:175], a[248:251], a[36:39], v[172:175]
ds_read_b64_tr_b16 a[12:13], v19 offset:32768
v_cvt_pk_bf16_f32 v118, v236, v237
v_mfma_f32_16x16x32_bf16 v[144:147], a[200:203], a[40:43], v[144:147]
ds_read_b64_tr_b16 a[14:15], v19 offset:33280
v_cvt_pk_bf16_f32 v119, v238, v239
v_mfma_f32_16x16x32_bf16 v[152:155], a[216:219], a[40:43], v[152:155]
v_cvt_pk_bf16_f32 v120, v240, v241
v_mfma_f32_16x16x32_bf16 v[176:179], a[232:235], a[40:43], v[176:179]
ds_read_b64_tr_b16 a[16:17], v26 offset:36864
v_cvt_pk_bf16_f32 v121, v242, v243
v_mfma_f32_16x16x32_bf16 v[184:187], a[248:251], a[40:43], v[184:187]
ds_read_b64_tr_b16 a[18:19], v26 offset:37376
v_cvt_pk_bf16_f32 v122, v244, v245
v_mfma_f32_16x16x32_bf16 v[148:151], a[200:203], a[44:47], v[148:151]
ds_read_b64_tr_b16 a[20:21], v18 offset:36864
v_cvt_pk_bf16_f32 v123, v246, v247
v_mfma_f32_16x16x32_bf16 v[156:159], a[216:219], a[44:47], v[156:159]
ds_read_b64_tr_b16 a[22:23], v18 offset:37376
v_mfma_f32_16x16x32_bf16 v[180:183], a[232:235], a[44:47], v[180:183]
v_cvt_pk_bf16_f32 v124, v248, v249
v_mfma_f32_16x16x32_bf16 v[188:191], a[248:251], a[44:47], v[188:191]
ds_read_b64_tr_b16 a[24:25], v27 offset:36864
v_cvt_pk_bf16_f32 v125, v250, v251
v_mfma_f32_16x16x32_bf16 v[128:131], a[204:207], a[48:51], v[128:131]
ds_read_b64_tr_b16 a[26:27], v27 offset:37376
v_cvt_pk_bf16_f32 v126, v252, v253
v_mfma_f32_16x16x32_bf16 v[136:139], a[220:223], a[48:51], v[136:139]
ds_read_b64_tr_b16 a[28:29], v19 offset:36864
v_cvt_pk_bf16_f32 v127, v254, v255
v_mfma_f32_16x16x32_bf16 v[160:163], a[236:239], a[48:51], v[160:163]
ds_read_b64_tr_b16 a[30:31], v19 offset:37376
v_permlane16_swap_b32 v112, v114
v_mfma_f32_16x16x32_bf16 v[168:171], a[252:255], a[48:51], v[168:171]
v_permlane16_swap_b32 v113, v115
v_mfma_f32_16x16x32_bf16 v[132:135], a[204:207], a[52:55], v[132:135]
v_mfma_f32_16x16x32_bf16 v[140:143], a[220:223], a[52:55], v[140:143]
v_permlane16_swap_b32 v116, v118
v_mfma_f32_16x16x32_bf16 v[164:167], a[236:239], a[52:55], v[164:167]
v_permlane16_swap_b32 v117, v119
v_mfma_f32_16x16x32_bf16 v[172:175], a[252:255], a[52:55], v[172:175]
v_permlane16_swap_b32 v120, v122
v_mfma_f32_16x16x32_bf16 v[144:147], a[204:207], a[56:59], v[144:147]
v_permlane16_swap_b32 v121, v123
v_mfma_f32_16x16x32_bf16 v[152:155], a[220:223], a[56:59], v[152:155]
v_permlane16_swap_b32 v124, v126
v_mfma_f32_16x16x32_bf16 v[176:179], a[236:239], a[56:59], v[176:179]
v_permlane16_swap_b32 v125, v127
v_mfma_f32_16x16x32_bf16 v[184:187], a[252:255], a[56:59], v[184:187]
v_mfma_f32_16x16x32_bf16 v[148:151], a[204:207], a[60:63], v[148:151]
v_mfma_f32_16x16x32_bf16 v[156:159], a[220:223], a[60:63], v[156:159]
v_mfma_f32_16x16x32_bf16 v[180:183], a[236:239], a[60:63], v[180:183]
v_mfma_f32_16x16x32_bf16 v[188:191], a[252:255], a[60:63], v[188:191]
s_waitcnt vmcnt(40)
v_mfma_f32_32x32x16_bf16 a[128:143], v[96:99], a[80:83], a[128:143]
v_mfma_f32_32x32x16_bf16 a[144:159], v[104:107], a[80:83], a[144:159]
v_mfma_f32_32x32x16_bf16 a[160:175], v[112:115], a[88:91], a[160:175]
v_mfma_f32_32x32x16_bf16 a[176:191], v[120:123], a[88:91], a[176:191]
v_mfma_f32_32x32x16_bf16 a[128:143], v[100:103], a[84:87], a[128:143]
v_mfma_f32_32x32x16_bf16 a[144:159], v[108:111], a[84:87], a[144:159]
v_mfma_f32_32x32x16_bf16 a[160:175], v[116:119], a[92:95], a[160:175]
v_mfma_f32_32x32x16_bf16 a[176:191], v[124:127], a[92:95], a[176:191]
s_waitcnt lgkmcnt(0)
s_waitcnt vmcnt(0)
v_mfma_f32_16x16x32_bf16 v[192:195], a[192:195], a[0:3], 0
ds_read_b64_tr_b16 a[32:33], v14 offset:0
v_mfma_f32_16x16x32_bf16 v[200:203], a[208:211], a[0:3], 0
ds_read_b64_tr_b16 a[34:35], v14 offset:512
v_mfma_f32_16x16x32_bf16 v[224:227], a[224:227], a[0:3], 0
ds_read_b64_tr_b16 a[36:37], v20 offset:0
v_mfma_f32_16x16x32_bf16 v[232:235], a[240:243], a[0:3], 0
ds_read_b64_tr_b16 a[38:39], v20 offset:512
v_mfma_f32_16x16x32_bf16 v[196:199], a[192:195], a[4:7], 0
v_cvt_pk_bf16_f32 v32, v128, v129
v_mfma_f32_16x16x32_bf16 v[204:207], a[208:211], a[4:7], 0
ds_read_b64_tr_b16 a[40:41], v15 offset:0
v_cvt_pk_bf16_f32 v33, v130, v131
v_mfma_f32_16x16x32_bf16 v[228:231], a[224:227], a[4:7], 0
ds_read_b64_tr_b16 a[42:43], v15 offset:512
v_cvt_pk_bf16_f32 v34, v132, v133
v_mfma_f32_16x16x32_bf16 v[236:239], a[240:243], a[4:7], 0
ds_read_b64_tr_b16 a[44:45], v21 offset:0
v_cvt_pk_bf16_f32 v35, v134, v135
v_mfma_f32_16x16x32_bf16 v[208:211], a[192:195], a[8:11], 0
ds_read_b64_tr_b16 a[46:47], v21 offset:512
v_cvt_pk_bf16_f32 v36, v136, v137
v_mfma_f32_16x16x32_bf16 v[216:219], a[208:211], a[8:11], 0
v_cvt_pk_bf16_f32 v37, v138, v139
v_mfma_f32_16x16x32_bf16 v[240:243], a[224:227], a[8:11], 0
ds_read_b64_tr_b16 a[48:49], v14 offset:4096
v_cvt_pk_bf16_f32 v38, v140, v141
v_mfma_f32_16x16x32_bf16 v[248:251], a[240:243], a[8:11], 0
ds_read_b64_tr_b16 a[50:51], v14 offset:4608
v_cvt_pk_bf16_f32 v39, v142, v143
v_mfma_f32_16x16x32_bf16 v[212:215], a[192:195], a[12:15], 0
ds_read_b64_tr_b16 a[52:53], v20 offset:4096
v_cvt_pk_bf16_f32 v40, v144, v145
v_mfma_f32_16x16x32_bf16 v[220:223], a[208:211], a[12:15], 0
ds_read_b64_tr_b16 a[54:55], v20 offset:4608
v_cvt_pk_bf16_f32 v41, v146, v147
v_mfma_f32_16x16x32_bf16 v[244:247], a[224:227], a[12:15], 0
v_cvt_pk_bf16_f32 v42, v148, v149
v_mfma_f32_16x16x32_bf16 v[252:255], a[240:243], a[12:15], 0
ds_read_b64_tr_b16 a[56:57], v15 offset:4096
v_cvt_pk_bf16_f32 v43, v150, v151
v_mfma_f32_16x16x32_bf16 v[192:195], a[196:199], a[16:19], v[192:195]
ds_read_b64_tr_b16 a[58:59], v15 offset:4608
v_cvt_pk_bf16_f32 v44, v152, v153
v_mfma_f32_16x16x32_bf16 v[200:203], a[212:215], a[16:19], v[200:203]
ds_read_b64_tr_b16 a[60:61], v21 offset:4096
v_cvt_pk_bf16_f32 v45, v154, v155
v_mfma_f32_16x16x32_bf16 v[224:227], a[228:231], a[16:19], v[224:227]
ds_read_b64_tr_b16 a[62:63], v21 offset:4608
v_cvt_pk_bf16_f32 v46, v156, v157
v_mfma_f32_16x16x32_bf16 v[232:235], a[244:247], a[16:19], v[232:235]
v_cvt_pk_bf16_f32 v47, v158, v159
v_mfma_f32_16x16x32_bf16 v[196:199], a[196:199], a[20:23], v[196:199]
v_permlane16_swap_b32 v32, v34
v_mfma_f32_16x16x32_bf16 v[204:207], a[212:215], a[20:23], v[204:207]
v_permlane16_swap_b32 v33, v35
v_mfma_f32_16x16x32_bf16 v[228:231], a[228:231], a[20:23], v[228:231]
v_permlane16_swap_b32 v36, v38
v_mfma_f32_16x16x32_bf16 v[236:239], a[244:247], a[20:23], v[236:239]
v_permlane16_swap_b32 v37, v39
v_mfma_f32_16x16x32_bf16 v[208:211], a[196:199], a[24:27], v[208:211]
v_permlane16_swap_b32 v40, v42
v_mfma_f32_16x16x32_bf16 v[216:219], a[212:215], a[24:27], v[216:219]
v_permlane16_swap_b32 v41, v43
v_mfma_f32_16x16x32_bf16 v[240:243], a[228:231], a[24:27], v[240:243]
v_permlane16_swap_b32 v44, v46
v_mfma_f32_16x16x32_bf16 v[248:251], a[244:247], a[24:27], v[248:251]
v_permlane16_swap_b32 v45, v47
v_mfma_f32_16x16x32_bf16 v[212:215], a[196:199], a[28:31], v[212:215]
v_mfma_f32_16x16x32_bf16 v[220:223], a[212:215], a[28:31], v[220:223]
v_mfma_f32_16x16x32_bf16 v[244:247], a[228:231], a[28:31], v[244:247]
v_mfma_f32_16x16x32_bf16 v[252:255], a[244:247], a[28:31], v[252:255]
s_waitcnt lgkmcnt(0)
v_mfma_f32_16x16x32_bf16 v[192:195], a[200:203], a[32:35], v[192:195]
v_add_u32 v8, s48, v31
v_cvt_pk_bf16_f32 v48, v160, v161
v_mfma_f32_16x16x32_bf16 v[200:203], a[216:219], a[32:35], v[200:203]
v_cvt_pk_bf16_f32 v49, v162, v163
v_mfma_f32_16x16x32_bf16 v[224:227], a[232:235], a[32:35], v[224:227]
v_cvt_pk_bf16_f32 v50, v164, v165
v_mfma_f32_16x16x32_bf16 v[232:235], a[248:251], a[32:35], v[232:235]
v_cvt_pk_bf16_f32 v51, v166, v167
v_mfma_f32_16x16x32_bf16 v[196:199], a[200:203], a[36:39], v[196:199]
v_cvt_pk_bf16_f32 v52, v168, v169
v_mfma_f32_16x16x32_bf16 v[204:207], a[216:219], a[36:39], v[204:207]
v_cvt_pk_bf16_f32 v53, v170, v171
v_mfma_f32_16x16x32_bf16 v[228:231], a[232:235], a[36:39], v[228:231]
v_and_b32 v1, 31, v0
v_lshrrev_b32 v9, 5, v0
v_lshlrev_b32 v9, 4, v9
v_lshl_add_u32 v9, v1, 12, v9
v_mfma_f32_16x16x32_bf16 v[236:239], a[248:251], a[36:39], v[236:239]
v_cvt_pk_bf16_f32 v54, v172, v173
v_mfma_f32_16x16x32_bf16 v[208:211], a[200:203], a[40:43], v[208:211]
v_cvt_pk_bf16_f32 v55, v174, v175
v_mfma_f32_16x16x32_bf16 v[216:219], a[216:219], a[40:43], v[216:219]
v_cvt_pk_bf16_f32 v56, v176, v177
v_mfma_f32_16x16x32_bf16 v[240:243], a[232:235], a[40:43], v[240:243]
v_cvt_pk_bf16_f32 v57, v178, v179
v_mfma_f32_16x16x32_bf16 v[248:251], a[248:251], a[40:43], v[248:251]
v_cvt_pk_bf16_f32 v58, v180, v181
v_mfma_f32_16x16x32_bf16 v[212:215], a[200:203], a[44:47], v[212:215]
v_cvt_pk_bf16_f32 v59, v182, v183
v_mfma_f32_16x16x32_bf16 v[220:223], a[216:219], a[44:47], v[220:223]
s_lshl_b32 s7, s44, 1
s_add_u32 s7, s7, s81
s_lshl_b32 s7, s7, 17
s_lshl_b32 s45, s5, 11
s_add_u32 s7, s7, s45
s_lshl_b32 s45, s43, 7
s_add_u32 s7, s7, s45
s_and_b32 s45, s6, 1
s_lshl_b32 s45, s45, 6
s_add_u32 s7, s7, s45
v_mfma_f32_16x16x32_bf16 v[244:247], a[232:235], a[44:47], v[244:247]
v_cvt_pk_bf16_f32 v60, v184, v185
v_mfma_f32_16x16x32_bf16 v[252:255], a[248:251], a[44:47], v[252:255]
v_cvt_pk_bf16_f32 v61, v186, v187
v_mfma_f32_16x16x32_bf16 v[192:195], a[204:207], a[48:51], v[192:195]
v_cvt_pk_bf16_f32 v62, v188, v189
v_mfma_f32_16x16x32_bf16 v[200:203], a[220:223], a[48:51], v[200:203]
v_cvt_pk_bf16_f32 v63, v190, v191
v_mfma_f32_16x16x32_bf16 v[224:227], a[236:239], a[48:51], v[224:227]
v_permlane16_swap_b32 v48, v50
v_mfma_f32_16x16x32_bf16 v[232:235], a[252:255], a[48:51], v[232:235]
v_permlane16_swap_b32 v49, v51
v_mfma_f32_16x16x32_bf16 v[196:199], a[204:207], a[52:55], v[196:199]
v_xor_b32 v10, 0x2000, v8
v_mfma_f32_16x16x32_bf16 v[204:207], a[220:223], a[52:55], v[204:207]
v_permlane16_swap_b32 v52, v54
v_mfma_f32_16x16x32_bf16 v[228:231], a[236:239], a[52:55], v[228:231]
v_permlane16_swap_b32 v53, v55
v_mfma_f32_16x16x32_bf16 v[236:239], a[252:255], a[52:55], v[236:239]
v_permlane16_swap_b32 v56, v58
v_mfma_f32_16x16x32_bf16 v[208:211], a[204:207], a[56:59], v[208:211]
v_permlane16_swap_b32 v57, v59
v_mfma_f32_16x16x32_bf16 v[216:219], a[220:223], a[56:59], v[216:219]
v_permlane16_swap_b32 v60, v62
v_mfma_f32_16x16x32_bf16 v[240:243], a[236:239], a[56:59], v[240:243]
v_xor_b32 v11, 0x4000, v8
v_permlane16_swap_b32 v61, v63
v_mfma_f32_16x16x32_bf16 v[248:251], a[252:255], a[56:59], v[248:251]
v_mfma_f32_16x16x32_bf16 v[212:215], a[204:207], a[60:63], v[212:215]
v_mfma_f32_16x16x32_bf16 v[220:223], a[220:223], a[60:63], v[220:223]
v_mfma_f32_16x16x32_bf16 v[244:247], a[236:239], a[60:63], v[244:247]
v_mfma_f32_16x16x32_bf16 v[252:255], a[252:255], a[60:63], v[252:255]
s_waitcnt vmcnt(28)
v_mfma_f32_32x32x16_bf16 a[128:143], v[32:35], a[96:99], a[128:143]
v_mfma_f32_32x32x16_bf16 a[144:159], v[40:43], a[96:99], a[144:159]
v_xor_b32 v12, 0x6000, v8
v_mfma_f32_32x32x16_bf16 a[160:175], v[48:51], a[104:107], a[160:175]
v_mfma_f32_32x32x16_bf16 a[176:191], v[56:59], a[104:107], a[176:191]
v_mfma_f32_32x32x16_bf16 a[128:143], v[36:39], a[100:103], a[128:143]
v_mfma_f32_32x32x16_bf16 a[144:159], v[44:47], a[100:103], a[144:159]
v_mfma_f32_32x32x16_bf16 a[160:175], v[52:55], a[108:111], a[160:175]
v_mfma_f32_32x32x16_bf16 a[176:191], v[60:63], a[108:111], a[176:191]
s_nop 3
s_waitcnt vmcnt(16)
v_cvt_pk_bf16_f32 v72, v208, v209
v_cvt_pk_bf16_f32 v73, v210, v211
v_cvt_pk_bf16_f32 v74, v212, v213
v_cvt_pk_bf16_f32 v75, v214, v215
v_cvt_pk_bf16_f32 v76, v216, v217
v_cvt_pk_bf16_f32 v77, v218, v219
v_cvt_pk_bf16_f32 v78, v220, v221
v_cvt_pk_bf16_f32 v79, v222, v223
s_nop 1
v_permlane16_swap_b32 v72, v74
v_permlane16_swap_b32 v73, v75
v_permlane16_swap_b32 v76, v78
v_permlane16_swap_b32 v77, v79
s_nop 1
v_mfma_f32_32x32x16_bf16 a[144:159], v[72:75], a[112:115], a[144:159]
v_mfma_f32_32x32x16_bf16 a[144:159], v[76:79], a[116:119], a[144:159]
v_cvt_pk_bf16_f32 v80, v224, v225
v_cvt_pk_bf16_f32 v81, v226, v227
v_cvt_pk_bf16_f32 v82, v228, v229
v_cvt_pk_bf16_f32 v83, v230, v231
v_cvt_pk_bf16_f32 v84, v232, v233
v_cvt_pk_bf16_f32 v85, v234, v235
v_cvt_pk_bf16_f32 v86, v236, v237
v_cvt_pk_bf16_f32 v87, v238, v239
s_nop 1
v_permlane16_swap_b32 v80, v82
v_permlane16_swap_b32 v81, v83
v_permlane16_swap_b32 v84, v86
v_permlane16_swap_b32 v85, v87
s_nop 1
v_mfma_f32_32x32x16_bf16 a[160:175], v[80:83], a[120:123], a[160:175]
v_mfma_f32_32x32x16_bf16 a[160:175], v[84:87], a[124:127], a[160:175]
v_cvt_pk_bf16_f32 v88, v240, v241
v_cvt_pk_bf16_f32 v89, v242, v243
v_cvt_pk_bf16_f32 v90, v244, v245
v_cvt_pk_bf16_f32 v91, v246, v247
v_cvt_pk_bf16_f32 v92, v248, v249
v_cvt_pk_bf16_f32 v93, v250, v251
v_cvt_pk_bf16_f32 v94, v252, v253
v_cvt_pk_bf16_f32 v95, v254, v255
s_nop 1
v_permlane16_swap_b32 v88, v90
v_permlane16_swap_b32 v89, v91
v_permlane16_swap_b32 v92, v94
v_permlane16_swap_b32 v93, v95
s_nop 1
ds_write_b128 v8, a[144:147] offset:0
ds_write_b128 v8, a[148:151] offset:1024
ds_write_b128 v8, a[152:155] offset:2048
ds_write_b128 v8, a[156:159] offset:3072
v_mfma_f32_32x32x16_bf16 a[176:191], v[88:91], a[120:123], a[176:191]
v_mfma_f32_32x32x16_bf16 a[176:191], v[92:95], a[124:127], a[176:191]
v_cvt_pk_bf16_f32 v64, v192, v193
v_cvt_pk_bf16_f32 v65, v194, v195
v_cvt_pk_bf16_f32 v66, v196, v197
v_cvt_pk_bf16_f32 v67, v198, v199
v_cvt_pk_bf16_f32 v68, v200, v201
v_cvt_pk_bf16_f32 v69, v202, v203
v_cvt_pk_bf16_f32 v70, v204, v205
v_cvt_pk_bf16_f32 v71, v206, v207
s_nop 1
v_permlane16_swap_b32 v64, v66
v_permlane16_swap_b32 v65, v67
v_permlane16_swap_b32 v68, v70
v_permlane16_swap_b32 v69, v71
s_nop 1
ds_write_b128 v8, a[160:163] offset:4096
ds_write_b128 v8, a[164:167] offset:5120
ds_write_b128 v8, a[168:171] offset:6144
ds_write_b128 v8, a[172:175] offset:7168
v_mfma_f32_32x32x16_bf16 a[128:143], v[64:67], a[112:115], a[128:143]
v_mfma_f32_32x32x16_bf16 a[128:143], v[68:71], a[116:119], a[128:143]
s_nop 1
ds_write_b128 v8, a[176:179] offset:32768
ds_write_b128 v8, a[180:183] offset:33792
ds_write_b128 v8, a[184:187] offset:34816
ds_write_b128 v8, a[188:191] offset:35840
s_nop 7
v_accvgpr_read_b32 v32, a128
v_accvgpr_read_b32 v33, a129
v_accvgpr_read_b32 v34, a130
v_accvgpr_read_b32 v35, a131
v_accvgpr_read_b32 v36, a132
v_accvgpr_read_b32 v37, a133
v_accvgpr_read_b32 v38, a134
v_accvgpr_read_b32 v39, a135
v_accvgpr_read_b32 v40, a136
v_accvgpr_read_b32 v41, a137
v_accvgpr_read_b32 v42, a138
v_accvgpr_read_b32 v43, a139
v_accvgpr_read_b32 v44, a140
v_accvgpr_read_b32 v45, a141
v_accvgpr_read_b32 v46, a142
v_accvgpr_read_b32 v47, a143
s_waitcnt lgkmcnt(0)
s_barrier
ds_read_b128 v[48:51], v10 offset:0
ds_read_b128 v[64:67], v11 offset:4096
ds_read_b128 v[80:83], v12 offset:32768
ds_read_b128 v[52:55], v10 offset:1024
ds_read_b128 v[68:71], v11 offset:5120
ds_read_b128 v[84:87], v12 offset:33792
ds_read_b128 v[56:59], v10 offset:2048
ds_read_b128 v[72:75], v11 offset:6144
ds_read_b128 v[88:91], v12 offset:34816
ds_read_b128 v[60:63], v10 offset:3072
ds_read_b128 v[76:79], v11 offset:7168
ds_read_b128 v[92:95], v12 offset:35840
s_waitcnt lgkmcnt(9)
v_add_f32 v32, v32, v48
v_add_f32 v64, v64, v80
v_add_f32 v33, v33, v49
v_add_f32 v65, v65, v81
v_add_f32 v34, v34, v50
v_add_f32 v66, v66, v82
v_add_f32 v35, v35, v51
v_add_f32 v67, v67, v83
v_add_f32 v32, v32, v64
v_add_f32 v33, v33, v65
v_add_f32 v34, v34, v66
v_add_f32 v35, v35, v67
v_cvt_pk_bf16_f32 v96, v32, v33
v_cvt_pk_bf16_f32 v97, v34, v35
s_waitcnt lgkmcnt(6)
v_add_f32 v36, v36, v52
v_add_f32 v68, v68, v84
v_add_f32 v37, v37, v53
v_add_f32 v69, v69, v85
v_add_f32 v38, v38, v54
v_add_f32 v70, v70, v86
v_add_f32 v39, v39, v55
v_add_f32 v71, v71, v87
v_add_f32 v36, v36, v68
v_add_f32 v37, v37, v69
v_add_f32 v38, v38, v70
v_add_f32 v39, v39, v71
v_cvt_pk_bf16_f32 v98, v36, v37
v_cvt_pk_bf16_f32 v99, v38, v39
s_nop 1
v_permlane32_swap_b32 v96, v98
v_permlane32_swap_b32 v97, v99
buffer_store_dwordx4 v[96:99], v9, s[28:31], s7 offen offset:0
s_waitcnt lgkmcnt(3)
v_add_f32 v40, v40, v56
v_add_f32 v72, v72, v88
v_add_f32 v41, v41, v57
v_add_f32 v73, v73, v89
v_add_f32 v42, v42, v58
v_add_f32 v74, v74, v90
v_add_f32 v43, v43, v59
v_add_f32 v75, v75, v91
v_add_f32 v40, v40, v72
v_add_f32 v41, v41, v73
v_add_f32 v42, v42, v74
v_add_f32 v43, v43, v75
v_cvt_pk_bf16_f32 v100, v40, v41
v_cvt_pk_bf16_f32 v101, v42, v43
s_waitcnt lgkmcnt(0)
v_add_f32 v44, v44, v60
v_add_f32 v76, v76, v92
v_add_f32 v45, v45, v61
v_add_f32 v77, v77, v93
v_add_f32 v46, v46, v62
v_add_f32 v78, v78, v94
v_add_f32 v47, v47, v63
v_add_f32 v79, v79, v95
v_add_f32 v44, v44, v76
v_add_f32 v45, v45, v77
v_add_f32 v46, v46, v78
v_add_f32 v47, v47, v79
v_cvt_pk_bf16_f32 v102, v44, v45
v_cvt_pk_bf16_f32 v103, v46, v47
s_nop 1
v_permlane32_swap_b32 v100, v102
v_permlane32_swap_b32 v101, v103
buffer_store_dwordx4 v[100:103], v9, s[28:31], s7 offen offset:32
L_end:
s_endpgm
.section .rodata,"a"
.p2align 6
.amdhsa_kernel concat_heads__gqa_block_cached__gqa_block_cached__near_ridge_kernel
  .amdhsa_next_free_vgpr 512
  .amdhsa_next_free_sgpr 96
  .amdhsa_accum_offset 256
  .amdhsa_group_segment_fixed_size 0
  .amdhsa_kernarg_size 104
  .amdhsa_user_sgpr_count 2
  .amdhsa_user_sgpr_kernarg_segment_ptr 1
  .amdhsa_system_sgpr_workgroup_id_x 1
.end_amdhsa_kernel
```
